```python
import torch

def _softmax(x, axis=-1):
    return torch.softmax(x, dim=axis)

def _gelu(x):
    return torch.nn.functional.gelu(x, approximate='tanh')

def _silu(x):
    return torch.nn.functional.silu(x)

def _sigmoid(x):
    return torch.sigmoid(x)

def _layernorm(x, axis=-1, eps=1e-05):
    m = x.mean(dim=axis, keepdim=True)
    v = x.var(dim=axis, keepdim=True, unbiased=False)
    return (x - m) / torch.sqrt(v + eps)

def _scatter_add(tgt, idx, src, axis=0):
    return tgt.clone().index_add_(axis, idx, src)

def _segment_sum(src, seg, n):
    out = torch.zeros((n,) + src.shape[1:], dtype=src.dtype)
    return out.index_add_(0, seg, src)

def _pad(x, pw):
    flat = tuple((v for pair in reversed(pw) for v in pair))
    return torch.nn.functional.pad(x, flat)
kernel_name = 'standalone__video_video_swin__vision'

def setup_inputs():

    _w = lambda a: (lambda t: t.to(torch.bfloat16) if t.is_floating_point() else t)(torch.as_tensor(a))
    T = 4
    H = W = 224 // 8 * 8
    C, win = (96, 8)
    return {'x': _w((lambda *s: torch.randn(*s, dtype=torch.bfloat16) * 0.1)(1, T, H, W, C)), 'wqkv_t': _w((lambda *s: torch.randn(*s, dtype=torch.bfloat16) * 0.1)(C, 3 * C)), 'wo_t': _w((lambda *s: torch.randn(*s, dtype=torch.bfloat16) * 0.1)(C, C)), 'wqkv_s': _w((lambda *s: torch.randn(*s, dtype=torch.bfloat16) * 0.1)(C, 3 * C)), 'wo_s': _w((lambda *s: torch.randn(*s, dtype=torch.bfloat16) * 0.8)(C, C))}

def reference(x, wqkv_t, wo_t, wqkv_s, wo_s):
    B, T, H, W, C = x.shape
    win = 8
    scale = C ** (-0.5)
    h = _layernorm(x, axis=-1)
    ht = (lambda x, *d: x.permute(*d))(h, 0, 2, 3, 1, 4).reshape(B * H * W, T, C)
    qkv = ht @ wqkv_t
    q, k, v = (qkv[..., :C].clone(), qkv[..., C:2 * C].clone(), qkv[..., 2 * C:].clone())
    p = _softmax(torch.einsum('btc,bsc->bts', q, k) * scale, axis=-1)
    ot = torch.einsum('bts,bsc->btc', p, v) @ wo_t
    ot = (lambda x, *d: x.permute(*d))(ot.reshape(B, H, W, T, C), 0, 3, 1, 2, 4)
    x = x + ot
    h = _layernorm(x, axis=-1)
    nh, nw = (H // win, W // win)
    hs = h.reshape(B * T, nh, win, nw, win, C)
    hw = (lambda x, *d: x.permute(*d))(hs, 0, 1, 3, 2, 4, 5).reshape(B * T * nh * nw, win * win, C)
    qkv = hw @ wqkv_s
    q, k, v = (qkv[..., :C].clone(), qkv[..., C:2 * C].clone(), qkv[..., 2 * C:].clone())
    p = _softmax(torch.einsum('bqc,bkc->bqk', q, k) * scale, axis=-1)
    os = torch.einsum('bqk,bkc->bqc', p, v) @ wo_s
    os = (lambda x, *d: x.permute(*d))(os.reshape(B * T, nh, nw, win, win, C), 0, 1, 3, 2, 4, 5)
    os = os.reshape(B, T, H, W, C)
    return x + os
```

```asm
; @launch grid=(256,1,1) block=(512,1,1) lds=153664
.amdgcn_target "amdgcn-amd-amdhsa--gfx950"
.text
.globl standalone__video_video_swin__vision_kernel
.p2align 8
.type standalone__video_video_swin__vision_kernel,@function
standalone__video_video_swin__vision_kernel:
    s_cmp_ge_u32 s2, 256
    s_cbranch_scc1 L_end
    s_load_dwordx8 s[64:71], s[0:1], 0
    s_load_dwordx4 s[72:75], s[0:1], 32
    s_load_dwordx2 s[90:91], s[0:1], 48
    s_load_dwordx2 s[4:5], s[0:1], 56
    v_and_b32 v1, 63, v0
    v_lshrrev_b32 v10, 6, v0
    s_nop 0
    v_readfirstlane_b32 s32, v10
    s_nop 3
    s_lshr_b32 s33, s32, 2
    s_and_b32 s34, s32, 3
    s_lshl_b32 s39, s33, 5
    s_add_u32 s39, s39, 153600
    v_mov_b32 v8, s39
    v_mov_b32 v9, 1
    v_mov_b32 v12, 0
    v_mov_b32 v13, 0
    v_mov_b32 v14, 0
    v_mov_b32 v15, 0
    ds_write_b128 v8, v[12:15]
    ds_write_b128 v8, v[12:15] offset:16
    s_mov_b32 s99, 4
    v_lshlrev_b32 v6, 4, v1
    s_waitcnt lgkmcnt(0)
    s_barrier
    s_cmp_eq_u32 s33, 1
    s_cselect_b32 s76, s70, s66
    s_cselect_b32 s77, s71, s67
    s_cselect_b32 s80, s72, s68
    s_cselect_b32 s81, s73, s69
    s_cselect_b32 s86, 76800, 0
    s_mov_b32 s87, 56832
    s_cmov_b32 s87, 133632
    s_cmp_eq_u32 s34, 3
    s_cselect_b32 s76, s80, s76
    s_cselect_b32 s77, s81, s77
    s_mov_b32 s78, 55296
    s_cmov_b32 s78, 18432
    s_cselect_b32 s86, s87, s86
    s_mov_b32 s87, 3641
    s_cmov_b32 s87, 10924
    s_mul_i32 s39, s34, 18432
    s_cselect_b32 s39, 0, s39
    s_and_b32 s77, s77, 0xffff
    s_mov_b32 s79, 0x00020000
    buffer_load_dwordx4 v[120:123], v6, s[76:79], s39 offen offset:0
    buffer_load_dwordx4 v[124:127], v6, s[76:79], s39 offen offset:1024
    buffer_load_dwordx4 v[128:131], v6, s[76:79], s39 offen offset:2048
    buffer_load_dwordx4 v[132:135], v6, s[76:79], s39 offen offset:3072
    s_add_u32 s39, s39, 4096
    buffer_load_dwordx4 v[136:139], v6, s[76:79], s39 offen offset:0
    buffer_load_dwordx4 v[140:143], v6, s[76:79], s39 offen offset:1024
    buffer_load_dwordx4 v[144:147], v6, s[76:79], s39 offen offset:2048
    buffer_load_dwordx4 v[148:151], v6, s[76:79], s39 offen offset:3072
    s_add_u32 s39, s39, 4096
    buffer_load_dwordx4 v[152:155], v6, s[76:79], s39 offen offset:0
    buffer_load_dwordx4 v[156:159], v6, s[76:79], s39 offen offset:1024
    buffer_load_dwordx4 v[160:163], v6, s[76:79], s39 offen offset:2048
    buffer_load_dwordx4 v[164:167], v6, s[76:79], s39 offen offset:3072
    s_add_u32 s39, s39, 4096
    buffer_load_dwordx4 v[168:171], v6, s[76:79], s39 offen offset:0
    buffer_load_dwordx4 v[172:175], v6, s[76:79], s39 offen offset:1024
    buffer_load_dwordx4 v[176:179], v6, s[76:79], s39 offen offset:2048
    buffer_load_dwordx4 v[180:183], v6, s[76:79], s39 offen offset:3072
    s_add_u32 s39, s39, 4096
    buffer_load_dwordx4 v[184:187], v6, s[76:79], s39 offen offset:0
    buffer_load_dwordx4 v[188:191], v6, s[76:79], s39 offen offset:1024
    s_sub_u32 s39, s39, 16384
    s_lshr_b32 s39, s39, 4
    v_lshrrev_b32 v24, 5, v1
    v_and_b32 v25, 31, v1
    v_bfe_u32 v29, v25, 2, 1
    v_and_b32 v30, 3, v25
    v_lshrrev_b32 v31, 3, v25
    v_lshl_add_u32 v30, v31, 2, v30
    v_mad_u32_u24 v26, v29, 48, v30
    s_movk_i32 s3, 592
    v_mul_u32_u24 v27, s3, v26
    v_lshl_add_u32 v27, v24, 4, v27
    v_lshrrev_b32 v31, 3, v30
    v_lshlrev_b32 v31, 4, v31
    v_lshl_add_u32 v31, v29, 3, v31
    v_and_b32 v28, 7, v30
    v_add_u32 v31, v31, v28
    s_movk_i32 s3, 208
    v_mul_u32_u24 v28, s3, v31
    s_movk_i32 s3, 96
    v_mad_u32_u24 v28, v24, s3, v28
    v_and_b32 v31, 1, v30
    v_lshlrev_b32 v31, 4, v31
    s_movk_i32 s3, 0x3f80
    v_lshlrev_b32 v31, v31, s3
    v_cmp_eq_u32 vcc, v29, v24
    s_nop 1
    v_cndmask_b32 v31, 0, v31, vcc
    v_lshrrev_b32 v30, 1, v30
    v_cmp_eq_u32 vcc, 0, v30
    s_nop 1
    v_cndmask_b32 v16, 0, v31, vcc
    v_cmp_eq_u32 vcc, 1, v30
    s_nop 1
    v_cndmask_b32 v17, 0, v31, vcc
    v_cmp_eq_u32 vcc, 2, v30
    s_nop 1
    v_cndmask_b32 v18, 0, v31, vcc
    v_cmp_eq_u32 vcc, 3, v30
    s_nop 1
    v_cndmask_b32 v19, 0, v31, vcc
    v_cmp_eq_u32 vcc, 4, v30
    s_nop 1
    v_cndmask_b32 v20, 0, v31, vcc
    v_cmp_eq_u32 vcc, 5, v30
    s_nop 1
    v_cndmask_b32 v21, 0, v31, vcc
    v_cmp_eq_u32 vcc, 6, v30
    s_nop 1
    v_cndmask_b32 v22, 0, v31, vcc
    v_cmp_eq_u32 vcc, 7, v30
    s_nop 1
    v_cndmask_b32 v23, 0, v31, vcc
    s_lshr_b32 s84, s32, 1
    s_and_b32 s85, s32, 1
    v_add_u32 v31, s39, v1
    v_mul_u32_u24 v50, s87, v31
    v_lshrrev_b32 v50, 17, v50
    v_add_u32 v50, v50, v31
    v_lshl_add_u32 v32, v50, 4, s86
    v_add_u32 v31, 64, v31
    v_mul_u32_u24 v50, s87, v31
    v_lshrrev_b32 v50, 17, v50
    v_add_u32 v50, v50, v31
    v_lshl_add_u32 v33, v50, 4, s86
    v_add_u32 v31, 64, v31
    v_mul_u32_u24 v50, s87, v31
    v_lshrrev_b32 v50, 17, v50
    v_add_u32 v50, v50, v31
    v_lshl_add_u32 v34, v50, 4, s86
    v_add_u32 v31, 64, v31
    v_mul_u32_u24 v50, s87, v31
    v_lshrrev_b32 v50, 17, v50
    v_add_u32 v50, v50, v31
    v_lshl_add_u32 v35, v50, 4, s86
    v_add_u32 v31, 64, v31
    v_mul_u32_u24 v50, s87, v31
    v_lshrrev_b32 v50, 17, v50
    v_add_u32 v50, v50, v31
    v_lshl_add_u32 v36, v50, 4, s86
    v_add_u32 v31, 64, v31
    v_mul_u32_u24 v50, s87, v31
    v_lshrrev_b32 v50, 17, v50
    v_add_u32 v50, v50, v31
    v_lshl_add_u32 v37, v50, 4, s86
    v_add_u32 v31, 64, v31
    v_mul_u32_u24 v50, s87, v31
    v_lshrrev_b32 v50, 17, v50
    v_add_u32 v50, v50, v31
    v_lshl_add_u32 v38, v50, 4, s86
    v_add_u32 v31, 64, v31
    v_mul_u32_u24 v50, s87, v31
    v_lshrrev_b32 v50, 17, v50
    v_add_u32 v50, v50, v31
    v_lshl_add_u32 v39, v50, 4, s86
    v_add_u32 v31, 64, v31
    v_mul_u32_u24 v50, s87, v31
    v_lshrrev_b32 v50, 17, v50
    v_add_u32 v50, v50, v31
    v_lshl_add_u32 v40, v50, 4, s86
    v_add_u32 v31, 64, v31
    v_mul_u32_u24 v50, s87, v31
    v_lshrrev_b32 v50, 17, v50
    v_add_u32 v50, v50, v31
    v_lshl_add_u32 v41, v50, 4, s86
    v_add_u32 v31, 64, v31
    v_mul_u32_u24 v50, s87, v31
    v_lshrrev_b32 v50, 17, v50
    v_add_u32 v50, v50, v31
    v_lshl_add_u32 v42, v50, 4, s86
    v_add_u32 v31, 64, v31
    v_mul_u32_u24 v50, s87, v31
    v_lshrrev_b32 v50, 17, v50
    v_add_u32 v50, v50, v31
    v_lshl_add_u32 v43, v50, 4, s86
    v_add_u32 v31, 64, v31
    v_mul_u32_u24 v50, s87, v31
    v_lshrrev_b32 v50, 17, v50
    v_add_u32 v50, v50, v31
    v_lshl_add_u32 v44, v50, 4, s86
    v_add_u32 v31, 64, v31
    v_mul_u32_u24 v50, s87, v31
    v_lshrrev_b32 v50, 17, v50
    v_add_u32 v50, v50, v31
    v_lshl_add_u32 v45, v50, 4, s86
    v_add_u32 v31, 64, v31
    v_mul_u32_u24 v50, s87, v31
    v_lshrrev_b32 v50, 17, v50
    v_add_u32 v50, v50, v31
    v_lshl_add_u32 v46, v50, 4, s86
    v_add_u32 v31, 64, v31
    v_mul_u32_u24 v50, s87, v31
    v_lshrrev_b32 v50, 17, v50
    v_add_u32 v50, v50, v31
    v_lshl_add_u32 v47, v50, 4, s86
    v_add_u32 v31, 64, v31
    v_mul_u32_u24 v50, s87, v31
    v_lshrrev_b32 v50, 17, v50
    v_add_u32 v50, v50, v31
    v_lshl_add_u32 v48, v50, 4, s86
    v_add_u32 v31, 64, v31
    v_mul_u32_u24 v50, s87, v31
    v_lshrrev_b32 v50, 17, v50
    v_add_u32 v50, v50, v31
    v_lshl_add_u32 v49, v50, 4, s86
    v_add_u32 v31, 64, v31
    s_mov_b32 s28, 0x3e16c740
    s_mov_b32 s29, 0x3c2aaaab
    s_mov_b32 s30, 0x3727c5ac
    s_mov_b32 s31, 0xffff0000
    s_mov_b32 s16, 0x000000ff
    s_mov_b32 s17, 0x000000ff
    s_mov_b32 s18, 0x0000ff00
    s_mov_b32 s19, 0x0000ff00
    s_mov_b32 s20, 0x00ff0000
    s_mov_b32 s21, 0x00ff0000
    s_mov_b32 s22, 0xff000000
    s_mov_b32 s23, 0xff000000
    s_mov_b32 s24, 0x0f0f0f0f
    s_mov_b32 s25, 0xf0f0f0f0
    s_lshl_b32 s37, 0x11111111, s34
    s_not_b32 s26, s37
    s_mov_b32 s27, s26
    v_add_u32 v0, 76800, v6
    v_cmp_eq_u32 vcc, 1, v24
    v_mov_b32 v29, 1024
    v_mov_b32 v30, 9633280
    v_cndmask_b32 v30, v29, v30, vcc
    v_add_u32 v7, v6, v30
    v_mov_b32 v30, 85504
    v_cndmask_b32 v30, v29, v30, vcc
    v_add_u32 v11, v6, v30
    v_mov_b32 v30, 1040
    v_cndmask_b32 v30, v29, v30, vcc
    s_mul_i32 s37, s33, 76800
    s_add_u32 s37, s37, 36864
    s_mul_i32 s38, s34, 9216
    s_add_u32 s38, s38, s37
    v_add_u32 v12, s38, v6
    v_add_u32 v13, v12, v30
    v_bfe_u32 v25, v1, 2, 3
    v_and_b32 v26, 3, v1
    v_mul_u32_u24 v29, 96, v24
    s_movk_i32 s3, 192
    v_mad_u32_u24 v29, v25, s3, v29
    s_movk_i32 s3, 1552
    v_mad_u32_u24 v29, v26, s3, v29
    v_add_u32 v2, s38, v29
    s_movk_i32 s3, 384
    v_mul_u32_u24 v29, s3, v24
    v_mad_u32_u24 v29, v25, 48, v29
    v_add_u32 v29, s37, v29
    s_sub_u32 s39, s34, 1
    v_sub_u32 v30, s39, v26
    v_and_b32 v30, 3, v30
    v_lshl_add_u32 v30, v30, 4, v29
    s_movk_i32 s3, 9216
    v_mad_u32_u24 v4, v26, s3, v30
    s_add_u32 s39, s34, 1
    v_subrev_u32 v30, s39, v26
    v_and_b32 v30, 3, v30
    v_lshl_add_u32 v30, v30, 4, v29
    s_mul_i32 s39, s34, 9216
    v_add_u32 v5, s39, v30
    s_mov_b32 s8, s64
    s_and_b32 s9, s65, 0xffff
    s_mov_b32 s10, 38535168
    s_mov_b32 s11, 0x00020000
    s_mov_b32 s12, s74
    s_and_b32 s13, s75, 0xffff
    s_mov_b32 s14, 38535168
    s_mov_b32 s15, 0x00020000
    s_and_b32 s5, s5, 0xffff
    s_mov_b32 s6, 38535168
    s_mov_b32 s7, 0x00020000
    s_mov_b32 s88, 0
    s_mov_b32 s97, 0
    s_cmp_ge_u32 s2, 16
    s_cbranch_scc1 L_u0_0
    s_cmp_lg_u32 s33, 0
    s_cbranch_scc1 L_u0_0
    s_sub_u32 s3, s2, 0
    s_add_u32 s96, s3, 4864
    s_add_u32 s98, s3, 0
    s_add_u32 s52, s3, 512
L_u0_0:
    s_cmp_ge_u32 s2, 16
    s_cbranch_scc1 L_u0_1
    s_cmp_lg_u32 s33, 1
    s_cbranch_scc1 L_u0_1
    s_sub_u32 s3, s2, 0
    s_add_u32 s96, s3, 256
    s_mov_b32 s98, 61440
    s_mov_b32 s52, 61440
L_u0_1:
    s_cmp_ge_u32 s2, 32
    s_cbranch_scc1 L_u1_0
    s_cmp_lt_u32 s2, 16
    s_cbranch_scc1 L_u1_0
    s_cmp_lg_u32 s33, 0
    s_cbranch_scc1 L_u1_0
    s_sub_u32 s3, s2, 16
    s_add_u32 s96, s3, 16
    s_add_u32 s98, s3, 528
    s_add_u32 s52, s3, 13056
L_u1_0:
    s_cmp_ge_u32 s2, 32
    s_cbranch_scc1 L_u1_1
    s_cmp_lt_u32 s2, 16
    s_cbranch_scc1 L_u1_1
    s_cmp_lg_u32 s33, 1
    s_cbranch_scc1 L_u1_1
    s_sub_u32 s3, s2, 16
    s_add_u32 s96, s3, 272
    s_mov_b32 s98, 61440
    s_mov_b32 s52, 61440
L_u1_1:
    s_cmp_ge_u32 s2, 256
    s_cbranch_scc1 L_u2_0
    s_cmp_lt_u32 s2, 32
    s_cbranch_scc1 L_u2_0
    s_cmp_lg_u32 s33, 0
    s_cbranch_scc1 L_u2_0
    s_sub_u32 s3, s2, 32
    s_add_u32 s96, s3, 32
    s_add_u32 s98, s3, 544
    s_mov_b32 s52, 61440
L_u2_0:
    s_cmp_ge_u32 s2, 256
    s_cbranch_scc1 L_u2_1
    s_cmp_lt_u32 s2, 32
    s_cbranch_scc1 L_u2_1
    s_cmp_lg_u32 s33, 1
    s_cbranch_scc1 L_u2_1
    s_sub_u32 s3, s2, 32
    s_add_u32 s96, s3, 288
    s_mov_b32 s98, 61440
    s_mov_b32 s52, 61440
L_u2_1:
    s_and_b32 s35, s96, 0xfff
    s_mul_hi_u32 s37, s35, 153391690
    s_mul_i32 s38, s37, 28
    s_sub_u32 s38, s35, s38
    s_mul_i32 s37, s37, 344064
    s_mul_i32 s38, s38, 1536
    s_add_u32 s89, s37, s38
    s_mul_i32 s38, s34, 86016
    s_add_u32 s38, s38, s89
    s_add_u32 s40, s38, 0
    s_add_u32 s41, s38, 0
    s_add_u32 s42, s38, 9634304
    s_add_u32 s43, s38, 19267584
    s_add_u32 s44, s38, 19267584
    s_add_u32 s45, s38, 28901888
    s_add_u32 s46, s38, 43008
    s_add_u32 s47, s38, 43008
    s_add_u32 s48, s38, 9677312
    s_add_u32 s49, s38, 19310592
    s_add_u32 s50, s38, 19310592
    s_add_u32 s51, s38, 28944896
    s_cmp_eq_u32 s33, 1
    s_cbranch_scc1 L_g1a
    buffer_load_dwordx4 v[72:75], v6, s[8:11], s40 offen nt
    buffer_load_dwordx4 v[76:79], v7, s[8:11], s41 offen nt
    buffer_load_dwordx4 v[80:83], v6, s[8:11], s42 offen nt
    buffer_load_dwordx4 v[84:87], v6, s[8:11], s43 offen nt
    buffer_load_dwordx4 v[88:91], v7, s[8:11], s44 offen nt
    buffer_load_dwordx4 v[92:95], v6, s[8:11], s45 offen nt
    buffer_load_dwordx4 v[96:99], v6, s[8:11], s46 offen nt
    buffer_load_dwordx4 v[100:103], v7, s[8:11], s47 offen nt
    buffer_load_dwordx4 v[104:107], v6, s[8:11], s48 offen nt
    buffer_load_dwordx4 v[108:111], v6, s[8:11], s49 offen nt
    buffer_load_dwordx4 v[112:115], v7, s[8:11], s50 offen nt
    buffer_load_dwordx4 v[116:119], v6, s[8:11], s51 offen nt
    s_waitcnt vmcnt(12)
    s_branch L_g1b
L_g1a:
    s_waitcnt vmcnt(0)
L_g1b:
    ds_write_b128 v32, v[120:123]
    ds_write_b128 v33, v[124:127]
    ds_write_b128 v34, v[128:131]
    ds_write_b128 v35, v[132:135]
    ds_write_b128 v36, v[136:139]
    ds_write_b128 v37, v[140:143]
    ds_write_b128 v38, v[144:147]
    ds_write_b128 v39, v[148:151]
    ds_write_b128 v40, v[152:155]
    ds_write_b128 v41, v[156:159]
    ds_write_b128 v42, v[160:163]
    ds_write_b128 v43, v[164:167]
    ds_write_b128 v44, v[168:171]
    ds_write_b128 v45, v[172:175]
    ds_write_b128 v46, v[176:179]
    ds_write_b128 v47, v[180:183]
    ds_write_b128 v48, v[184:187]
    ds_write_b128 v49, v[188:191]
    s_waitcnt lgkmcnt(0)
    s_mov_b64 exec, 1
    ds_add_u32 v8, v9 offset:8
    s_mov_b64 exec, -1
L_pA:
    ds_read_b32 v10, v8 offset:8
    s_waitcnt lgkmcnt(0)
    v_readfirstlane_b32 s37, v10
    s_nop 3
    s_cmp_ge_u32 s37, s99
    s_cbranch_scc1 L_pA_go
    s_sleep 1
    s_branch L_pA
L_pA_go:
    s_cmp_eq_u32 s33, 0
    s_cbranch_scc1 L_g1c
    buffer_load_dwordx4 v[72:75], v6, s[8:11], s40 offen nt
    buffer_load_dwordx4 v[76:79], v7, s[8:11], s41 offen nt
    buffer_load_dwordx4 v[80:83], v6, s[8:11], s42 offen nt
    buffer_load_dwordx4 v[84:87], v6, s[8:11], s43 offen nt
    buffer_load_dwordx4 v[88:91], v7, s[8:11], s44 offen nt
    buffer_load_dwordx4 v[92:95], v6, s[8:11], s45 offen nt
    buffer_load_dwordx4 v[96:99], v6, s[8:11], s46 offen nt
    buffer_load_dwordx4 v[100:103], v7, s[8:11], s47 offen nt
    buffer_load_dwordx4 v[104:107], v6, s[8:11], s48 offen nt
    buffer_load_dwordx4 v[108:111], v6, s[8:11], s49 offen nt
    buffer_load_dwordx4 v[112:115], v7, s[8:11], s50 offen nt
    buffer_load_dwordx4 v[116:119], v6, s[8:11], s51 offen nt
L_g1c:
    s_cmp_ge_u32 s84, 2
    s_cselect_b32 s86, 76800, 0
    s_mov_b32 s87, 56832
    s_cmov_b32 s87, 133632
    s_and_b32 s37, s84, 1
    s_mul_i32 s38, s37, 384
    s_add_u32 s38, s38, s86
    s_mul_i32 s39, s85, 18944
    s_add_u32 s3, s38, s39
    v_add_u32 v31, s3, v27
    ds_read_b128 v[120:123], v31 offset:0
    ds_read_b128 v[124:127], v31 offset:32
    ds_read_b128 v[128:131], v31 offset:64
    ds_read_b128 v[132:135], v31 offset:96
    ds_read_b128 v[136:139], v31 offset:128
    ds_read_b128 v[140:143], v31 offset:160
    s_add_u32 s3, s38, 9472
    v_add_u32 v31, s3, v27
    ds_read_b128 v[144:147], v31 offset:0
    ds_read_b128 v[148:151], v31 offset:32
    ds_read_b128 v[152:155], v31 offset:64
    ds_read_b128 v[156:159], v31 offset:96
    ds_read_b128 v[160:163], v31 offset:128
    ds_read_b128 v[164:167], v31 offset:160
    s_sub_u32 s3, s38, s39
    s_add_u32 s3, s3, 18944
    v_add_u32 v31, s3, v27
    ds_read_b128 v[168:171], v31 offset:0
    ds_read_b128 v[172:175], v31 offset:32
    ds_read_b128 v[176:179], v31 offset:64
    ds_read_b128 v[180:183], v31 offset:96
    ds_read_b128 v[184:187], v31 offset:128
    ds_read_b128 v[188:191], v31 offset:160
    s_cmp_eq_u32 s37, 1
    s_cbranch_scc1 L_prepU
    s_add_u32 s3, s86, s39
    v_add_u32 v31, s3, v27
    ds_read_b128 v[192:195], v31 offset:192
    ds_read_b128 v[196:199], v31 offset:224
    ds_read_b128 v[200:203], v31 offset:256
    ds_read_b128 v[204:207], v31 offset:288
    ds_read_b128 v[208:211], v31 offset:320
    ds_read_b128 v[212:215], v31 offset:352
    s_add_u32 s3, s86, 9472
    v_add_u32 v31, s3, v27
    ds_read_b128 v[216:219], v31 offset:192
    ds_read_b128 v[220:223], v31 offset:224
    ds_read_b128 v[224:227], v31 offset:256
    ds_read_b128 v[228:231], v31 offset:288
    ds_read_b128 v[232:235], v31 offset:320
    ds_read_b128 v[236:239], v31 offset:352
    s_branch L_prepL
L_prepU:
    s_lshl_b32 s3, s85, 6
    s_add_u32 s3, s3, s87
    v_add_u32 v31, s3, v28
    ds_read_b128 v[192:195], v31 offset:0
    ds_read_b128 v[196:199], v31 offset:16
    ds_read_b128 v[200:203], v31 offset:6656
    ds_read_b128 v[204:207], v31 offset:6672
    ds_read_b128 v[208:211], v31 offset:13312
    ds_read_b128 v[212:215], v31 offset:13328
    s_add_u32 s3, s87, 32
    v_add_u32 v31, s3, v28
    ds_read_b128 v[216:219], v31 offset:0
    ds_read_b128 v[220:223], v31 offset:16
    ds_read_b128 v[224:227], v31 offset:6656
    ds_read_b128 v[228:231], v31 offset:6672
    ds_read_b128 v[232:235], v31 offset:13312
    ds_read_b128 v[236:239], v31 offset:13328
L_prepL:
    s_waitcnt lgkmcnt(0)
    s_mov_b64 exec, 1
    ds_add_u32 v8, v9 offset:12
    s_mov_b64 exec, -1
    s_and_b32 s37, s84, 1
    s_cmp_eq_u32 s37, 0
    s_cbranch_scc1 L_prepM
    v_mfma_f32_32x32x16_bf16 v[24:39], v[192:195], v[16:19], 0
    v_mfma_f32_32x32x16_bf16 v[40:55], v[200:203], v[16:19], 0
    v_mfma_f32_32x32x16_bf16 v[56:71], v[208:211], v[16:19], 0
    v_mfma_f32_32x32x16_bf16 v[24:39], v[196:199], v[20:23], v[24:39]
    v_mfma_f32_32x32x16_bf16 v[40:55], v[204:207], v[20:23], v[40:55]
    v_mfma_f32_32x32x16_bf16 v[56:71], v[212:215], v[20:23], v[56:71]
    s_nop 9
    v_cvt_pk_bf16_f32 v192, v24, v25
    v_cvt_pk_bf16_f32 v193, v26, v27
    v_cvt_pk_bf16_f32 v194, v28, v29
    v_cvt_pk_bf16_f32 v195, v30, v31
    v_cvt_pk_bf16_f32 v196, v32, v33
    v_cvt_pk_bf16_f32 v197, v34, v35
    v_cvt_pk_bf16_f32 v198, v36, v37
    v_cvt_pk_bf16_f32 v199, v38, v39
    v_mfma_f32_32x32x16_bf16 v[24:39], v[216:219], v[16:19], 0
    v_cvt_pk_bf16_f32 v200, v40, v41
    v_cvt_pk_bf16_f32 v201, v42, v43
    v_cvt_pk_bf16_f32 v202, v44, v45
    v_cvt_pk_bf16_f32 v203, v46, v47
    v_cvt_pk_bf16_f32 v204, v48, v49
    v_cvt_pk_bf16_f32 v205, v50, v51
    v_mfma_f32_32x32x16_bf16 v[24:39], v[220:223], v[20:23], v[24:39]
    v_cvt_pk_bf16_f32 v206, v52, v53
    v_cvt_pk_bf16_f32 v207, v54, v55
    v_cvt_pk_bf16_f32 v208, v56, v57
    v_cvt_pk_bf16_f32 v209, v58, v59
    v_cvt_pk_bf16_f32 v210, v60, v61
    v_cvt_pk_bf16_f32 v211, v62, v63
    v_mfma_f32_32x32x16_bf16 v[40:55], v[224:227], v[16:19], 0
    v_cvt_pk_bf16_f32 v212, v64, v65
    v_cvt_pk_bf16_f32 v213, v66, v67
    v_cvt_pk_bf16_f32 v214, v68, v69
    v_cvt_pk_bf16_f32 v215, v70, v71
    v_mfma_f32_32x32x16_bf16 v[56:71], v[232:235], v[16:19], 0
    v_cvt_pk_bf16_f32 v216, v24, v25
    v_cvt_pk_bf16_f32 v217, v26, v27
    v_cvt_pk_bf16_f32 v218, v28, v29
    v_cvt_pk_bf16_f32 v219, v30, v31
    v_cvt_pk_bf16_f32 v220, v32, v33
    v_cvt_pk_bf16_f32 v221, v34, v35
    v_mfma_f32_32x32x16_bf16 v[40:55], v[228:231], v[20:23], v[40:55]
    v_cvt_pk_bf16_f32 v222, v36, v37
    v_cvt_pk_bf16_f32 v223, v38, v39
    v_mfma_f32_32x32x16_bf16 v[56:71], v[236:239], v[20:23], v[56:71]
    s_nop 8
    v_cvt_pk_bf16_f32 v224, v40, v41
    v_cvt_pk_bf16_f32 v225, v42, v43
    v_cvt_pk_bf16_f32 v226, v44, v45
    v_cvt_pk_bf16_f32 v227, v46, v47
    v_cvt_pk_bf16_f32 v228, v48, v49
    v_cvt_pk_bf16_f32 v229, v50, v51
    v_cvt_pk_bf16_f32 v230, v52, v53
    v_cvt_pk_bf16_f32 v231, v54, v55
    v_cvt_pk_bf16_f32 v232, v56, v57
    v_cvt_pk_bf16_f32 v233, v58, v59
    v_cvt_pk_bf16_f32 v234, v60, v61
    v_cvt_pk_bf16_f32 v235, v62, v63
    v_cvt_pk_bf16_f32 v236, v64, v65
    v_cvt_pk_bf16_f32 v237, v66, v67
    v_cvt_pk_bf16_f32 v238, v68, v69
    v_cvt_pk_bf16_f32 v239, v70, v71
L_prepM:
    s_nop 12
    v_mfma_f32_32x32x16_bf16 v[24:39], v[168:171], v[192:195], 0
    v_mfma_f32_32x32x16_bf16 v[40:55], v[120:123], v[192:195], 0
    v_mfma_f32_32x32x16_bf16 v[24:39], v[172:175], v[196:199], v[24:39]
    v_mfma_f32_32x32x16_bf16 v[40:55], v[124:127], v[196:199], v[40:55]
    v_mfma_f32_32x32x16_bf16 v[24:39], v[176:179], v[200:203], v[24:39]
    v_mfma_f32_32x32x16_bf16 v[40:55], v[128:131], v[200:203], v[40:55]
    v_mfma_f32_32x32x16_bf16 v[24:39], v[180:183], v[204:207], v[24:39]
    v_mfma_f32_32x32x16_bf16 v[40:55], v[132:135], v[204:207], v[40:55]
    v_mfma_f32_32x32x16_bf16 v[24:39], v[184:187], v[208:211], v[24:39]
    v_mfma_f32_32x32x16_bf16 v[40:55], v[136:139], v[208:211], v[40:55]
    v_mfma_f32_32x32x16_bf16 v[24:39], v[188:191], v[212:215], v[24:39]
    v_mfma_f32_32x32x16_bf16 v[40:55], v[140:143], v[212:215], v[40:55]
    v_mfma_f32_32x32x16_bf16 v[56:71], v[144:147], v[192:195], 0
    s_nop 9
    v_cvt_pk_bf16_f32 v240, v24, v25
    v_cvt_pk_bf16_f32 v241, v26, v27
    v_cvt_pk_bf16_f32 v242, v28, v29
    v_cvt_pk_bf16_f32 v243, v30, v31
    v_cvt_pk_bf16_f32 v244, v32, v33
    v_cvt_pk_bf16_f32 v245, v34, v35
    v_mfma_f32_32x32x16_bf16 v[56:71], v[148:151], v[196:199], v[56:71]
    v_cvt_pk_bf16_f32 v246, v36, v37
    v_cvt_pk_bf16_f32 v247, v38, v39
    v_cvt_pk_bf16_f32 v248, v40, v41
    v_cvt_pk_bf16_f32 v249, v42, v43
    v_cvt_pk_bf16_f32 v250, v44, v45
    v_cvt_pk_bf16_f32 v251, v46, v47
    v_mfma_f32_32x32x16_bf16 v[24:39], v[120:123], v[216:219], 0
    v_cvt_pk_bf16_f32 v252, v48, v49
    v_cvt_pk_bf16_f32 v253, v50, v51
    v_cvt_pk_bf16_f32 v254, v52, v53
    v_cvt_pk_bf16_f32 v255, v54, v55
    v_mfma_f32_32x32x16_bf16 v[40:55], v[144:147], v[216:219], 0
    v_mfma_f32_32x32x16_bf16 v[24:39], v[124:127], v[220:223], v[24:39]
    v_mfma_f32_32x32x16_bf16 v[40:55], v[148:151], v[220:223], v[40:55]
    v_mfma_f32_32x32x16_bf16 v[56:71], v[152:155], v[200:203], v[56:71]
    v_mfma_f32_32x32x16_bf16 v[24:39], v[128:131], v[224:227], v[24:39]
    v_mfma_f32_32x32x16_bf16 v[40:55], v[152:155], v[224:227], v[40:55]
    v_mfma_f32_32x32x16_bf16 v[56:71], v[156:159], v[204:207], v[56:71]
    v_mfma_f32_32x32x16_bf16 v[24:39], v[132:135], v[228:231], v[24:39]
    v_mfma_f32_32x32x16_bf16 v[40:55], v[156:159], v[228:231], v[40:55]
    v_mfma_f32_32x32x16_bf16 v[56:71], v[160:163], v[208:211], v[56:71]
    v_mfma_f32_32x32x16_bf16 v[24:39], v[136:139], v[232:235], v[24:39]
    v_mfma_f32_32x32x16_bf16 v[40:55], v[160:163], v[232:235], v[40:55]
    v_mfma_f32_32x32x16_bf16 v[56:71], v[164:167], v[212:215], v[56:71]
    v_mfma_f32_32x32x16_bf16 v[24:39], v[140:143], v[236:239], v[24:39]
    v_mfma_f32_32x32x16_bf16 v[40:55], v[164:167], v[236:239], v[40:55]
    s_nop 9
    v_cvt_pk_bf16_f32 v168, v56, v57
    v_cvt_pk_bf16_f32 v169, v58, v59
    v_cvt_pk_bf16_f32 v170, v60, v61
    v_cvt_pk_bf16_f32 v171, v62, v63
    v_cvt_pk_bf16_f32 v172, v64, v65
    v_cvt_pk_bf16_f32 v173, v66, v67
    v_cvt_pk_bf16_f32 v174, v68, v69
    v_cvt_pk_bf16_f32 v175, v70, v71
    v_cvt_pk_bf16_f32 v176, v24, v25
    v_cvt_pk_bf16_f32 v177, v26, v27
    v_cvt_pk_bf16_f32 v178, v28, v29
    v_cvt_pk_bf16_f32 v179, v30, v31
    v_cvt_pk_bf16_f32 v180, v32, v33
    v_cvt_pk_bf16_f32 v181, v34, v35
    v_cvt_pk_bf16_f32 v182, v36, v37
    v_cvt_pk_bf16_f32 v183, v38, v39
    v_cvt_pk_bf16_f32 v184, v40, v41
    v_cvt_pk_bf16_f32 v185, v42, v43
    v_cvt_pk_bf16_f32 v186, v44, v45
    v_cvt_pk_bf16_f32 v187, v46, v47
    v_cvt_pk_bf16_f32 v188, v48, v49
    v_cvt_pk_bf16_f32 v189, v50, v51
    v_cvt_pk_bf16_f32 v190, v52, v53
    v_cvt_pk_bf16_f32 v191, v54, v55
    s_mul_i32 s37, s84, 18432
    s_mul_i32 s38, s33, 39936
    s_add_u32 s37, s37, s38
    s_mul_i32 s38, s85, 12288
    s_add_u32 s38, s38, s37
    s_add_u32 s39, s37, 6144
    s_lshl_b32 s86, s85, 12
    s_sub_u32 s87, 4096, s86
    s_add_u32 s3, s38, s87
    v_add_u32 v120, s3, v6
    s_add_u32 s3, s38, s86
    v_add_u32 v121, s3, v6
    s_add_u32 s3, s38, 2048
    v_add_u32 v122, s3, v6
    s_add_u32 s3, s39, s86
    v_add_u32 v123, s3, v6
    s_add_u32 s3, s39, 2048
    v_add_u32 v124, s3, v6
L_pB:
    ds_read_b32 v10, v8 offset:12
    s_waitcnt lgkmcnt(0)
    v_readfirstlane_b32 s37, v10
    s_nop 3
    s_cmp_ge_u32 s37, s99
    s_cbranch_scc1 L_pB_go
    s_sleep 1
    s_branch L_pB
L_pB_go:
    ds_write_b128 v120, v[240:243] offset:0
    ds_write_b128 v120, v[244:247] offset:1024
    ds_write_b128 v121, v[248:251] offset:0
    ds_write_b128 v121, v[252:255] offset:1024
    ds_write_b128 v122, v[168:171] offset:0
    ds_write_b128 v122, v[172:175] offset:1024
    ds_write_b128 v123, v[176:179] offset:0
    ds_write_b128 v123, v[180:183] offset:1024
    ds_write_b128 v124, v[184:187] offset:0
    ds_write_b128 v124, v[188:191] offset:1024
    s_waitcnt lgkmcnt(0)
    s_mov_b64 exec, 1
    ds_add_u32 v8, v9 offset:16
    s_mov_b64 exec, -1
    v_bfe_u32 v14, v1, 2, 1
    v_bfe_u32 v15, v1, 4, 1
    v_cmp_eq_u32 vcc, v14, v15
    v_mov_b32 v14, 0x3f803f80
    s_nop 0
    v_cndmask_b32 v252, 0, v14, vcc
    v_cndmask_b32 v253, 0, v14, vcc
    v_cndmask_b32 v254, 0, v14, vcc
    v_cndmask_b32 v255, 0, v14, vcc
    v_mov_b32 v14, 153600
L_pC:
    ds_read_b32 v10, v14 offset:16
    s_waitcnt lgkmcnt(0)
    v_readfirstlane_b32 s37, v10
    s_nop 3
    s_cmp_ge_u32 s37, s99
    s_cbranch_scc1 L_pC_go
    s_sleep 1
    s_branch L_pC
L_pC_go:
    s_waitcnt vmcnt(0)
    s_nop 12
    s_mov_b32 s84, s52
L_loop:
    s_and_b32 s35, s96, 0xfff
    s_mul_hi_u32 s37, s35, 153391690
    s_mul_i32 s38, s37, 28
    s_sub_u32 s38, s35, s38
    s_mul_i32 s37, s37, 344064
    s_mul_i32 s38, s38, 1536
    s_add_u32 s89, s37, s38
    s_waitcnt vmcnt(12)
    s_add_u32 s88, s88, 1
    s_lshl_b32 s36, s88, 2
    ds_write_b128 v12, v[72:75] offset:0
    ds_write_b128 v13, v[76:79] offset:0
    ds_write_b128 v12, v[80:83] offset:2064
    ds_write_b128 v12, v[84:87] offset:3104
    ds_write_b128 v13, v[88:91] offset:3104
    ds_write_b128 v12, v[92:95] offset:5168
    ds_read_b128 v[24:27], v2 offset:0
    ds_read_b128 v[28:31], v2 offset:16
    ds_read_b128 v[32:35], v2 offset:32
    ds_read_b128 v[36:39], v2 offset:48
    ds_read_b128 v[40:43], v2 offset:64
    ds_read_b128 v[44:47], v2 offset:80
    ds_write_b128 v12, v[96:99] offset:0
    ds_write_b128 v13, v[100:103] offset:0
    ds_write_b128 v12, v[104:107] offset:2064
    ds_write_b128 v12, v[108:111] offset:3104
    ds_write_b128 v13, v[112:115] offset:3104
    ds_write_b128 v12, v[116:119] offset:5168
    ds_read_b128 v[48:51], v2 offset:0
    ds_read_b128 v[52:55], v2 offset:16
    ds_read_b128 v[56:59], v2 offset:32
    ds_read_b128 v[60:63], v2 offset:48
    ds_read_b128 v[64:67], v2 offset:64
    ds_read_b128 v[232:235], v6 offset:0
    ds_read_b128 v[68:71], v2 offset:80
    ds_read_b128 v[236:239], v6 offset:1024
    ds_read_b128 v[240:243], v6 offset:2048
    ds_read_b128 v[244:247], v6 offset:3072
    ds_read_b128 v[248:251], v6 offset:4096
    s_waitcnt lgkmcnt(10)
    v_mfma_f32_32x32x16_bf16 v[168:183], v[16:19], v[24:27], 0
    v_mfma_f32_32x32x16_bf16 v[168:183], v[20:23], v[28:31], v[168:183]
    v_mfma_f32_32x32x16_bf16 v[184:199], v[16:19], v[32:35], 0
    v_mfma_f32_16x16x32_bf16 v[216:219], v[252:255], v[24:27], 0
    s_nop 9
    v_mul_f32 v220, v168, v168
    v_mul_f32 v221, v169, v169
    v_mfma_f32_32x32x16_bf16 v[184:199], v[20:23], v[36:39], v[184:199]
    v_fmac_f32 v220, v170, v170
    v_fmac_f32 v221, v171, v171
    v_fmac_f32 v220, v172, v172
    v_fmac_f32 v221, v173, v173
    v_fmac_f32 v220, v174, v174
    v_fmac_f32 v221, v175, v175
    v_mfma_f32_16x16x32_bf16 v[216:219], v[252:255], v[28:31], v[216:219]
    v_fmac_f32 v220, v176, v176
    v_fmac_f32 v221, v177, v177
    v_mfma_f32_32x32x16_bf16 v[200:215], v[16:19], v[40:43], 0
    v_fmac_f32 v220, v178, v178
    v_fmac_f32 v221, v179, v179
    v_fmac_f32 v220, v180, v180
    v_fmac_f32 v221, v181, v181
    v_fmac_f32 v220, v182, v182
    v_fmac_f32 v221, v183, v183
    v_mfma_f32_16x16x32_bf16 v[216:219], v[252:255], v[32:35], v[216:219]
    v_fmac_f32 v220, v184, v184
    v_fmac_f32 v221, v185, v185
    v_mfma_f32_32x32x16_bf16 v[200:215], v[20:23], v[44:47], v[200:215]
    v_fmac_f32 v220, v186, v186
    v_fmac_f32 v221, v187, v187
    v_fmac_f32 v220, v188, v188
    v_fmac_f32 v221, v189, v189
    v_fmac_f32 v220, v190, v190
    v_fmac_f32 v221, v191, v191
    v_mfma_f32_16x16x32_bf16 v[216:219], v[252:255], v[36:39], v[216:219]
    v_fmac_f32 v220, v192, v192
    v_fmac_f32 v221, v193, v193
    v_mfma_f32_32x32x16_bf16 v[120:135], v[16:19], v[48:51], 0
    v_fmac_f32 v220, v194, v194
    v_fmac_f32 v221, v195, v195
    v_fmac_f32 v220, v196, v196
    v_fmac_f32 v221, v197, v197
    v_fmac_f32 v220, v198, v198
    v_fmac_f32 v221, v199, v199
    v_mfma_f32_16x16x32_bf16 v[216:219], v[252:255], v[40:43], v[216:219]
    v_fmac_f32 v220, v200, v200
    v_fmac_f32 v221, v201, v201
    s_waitcnt lgkmcnt(0)
    v_mfma_f32_32x32x16_bf16 v[120:135], v[20:23], v[52:55], v[120:135]
    v_fmac_f32 v220, v202, v202
    v_fmac_f32 v221, v203, v203
    v_fmac_f32 v220, v204, v204
    v_fmac_f32 v221, v205, v205
    v_fmac_f32 v220, v206, v206
    v_fmac_f32 v221, v207, v207
    v_mfma_f32_16x16x32_bf16 v[216:219], v[252:255], v[44:47], v[216:219]
    v_fmac_f32 v220, v208, v208
    v_fmac_f32 v221, v209, v209
    v_mfma_f32_32x32x16_bf16 v[136:151], v[16:19], v[56:59], 0
    v_fmac_f32 v220, v210, v210
    v_fmac_f32 v221, v211, v211
    v_fmac_f32 v220, v212, v212
    v_fmac_f32 v221, v213, v213
    v_fmac_f32 v220, v214, v214
    v_fmac_f32 v221, v215, v215
    v_mfma_f32_16x16x32_bf16 v[224:227], v[252:255], v[48:51], 0
    v_add_f32 v220, v220, v221
    v_mov_b32 v221, v220
    v_mfma_f32_32x32x16_bf16 v[136:151], v[20:23], v[60:63], v[136:151]
    s_nop 0
    v_permlane32_swap_b32 v220, v221
    v_add_f32 v220, v220, v221
    v_mul_f32 v216, s29, v216
    v_mul_f32 v220, s29, v220
    v_fma_f32 v220, -v216, v216, v220
    v_max_f32 v220, 0, v220
    v_mfma_f32_16x16x32_bf16 v[224:227], v[252:255], v[52:55], v[224:227]
    v_cvt_pk_bf16_f32 v220, v220, v220
    v_lshlrev_b32 v220, 16, v220
    v_mfma_f32_32x32x16_bf16 v[152:167], v[16:19], v[64:67], 0
    v_add_f32 v220, s30, v220
    v_cvt_pk_bf16_f32 v220, v220, v220
    v_lshlrev_b32 v220, 16, v220
    v_sqrt_f32 v220, v220
    v_cvt_pk_bf16_f32 v216, v216, v216
    v_mfma_f32_16x16x32_bf16 v[224:227], v[252:255], v[56:59], v[224:227]
    v_cvt_pk_bf16_f32 v220, v220, v220
    v_lshlrev_b32 v220, 16, v220
    v_mfma_f32_32x32x16_bf16 v[152:167], v[20:23], v[68:71], v[152:167]
    v_rcp_f32 v219, v220
    v_lshlrev_b32 v216, 16, v216
    v_mul_f32 v222, -v216, v219
    v_fma_f32 v168, v168, v219, v222
    v_fma_f32 v169, v169, v219, v222
    v_mfma_f32_16x16x32_bf16 v[224:227], v[252:255], v[60:63], v[224:227]
    v_fma_f32 v170, v170, v219, v222
    v_fma_f32 v171, v171, v219, v222
    v_fma_f32 v172, v172, v219, v222
    v_fma_f32 v173, v173, v219, v222
    v_fma_f32 v174, v174, v219, v222
    v_fma_f32 v175, v175, v219, v222
    v_mfma_f32_16x16x32_bf16 v[224:227], v[252:255], v[64:67], v[224:227]
    v_cvt_pk_bf16_f32 v72, v168, v169
    v_cvt_pk_bf16_f32 v73, v170, v171
    v_cvt_pk_bf16_f32 v74, v172, v173
    v_cvt_pk_bf16_f32 v75, v174, v175
    v_fma_f32 v184, v184, v219, v222
    v_fma_f32 v185, v185, v219, v222
    v_mfma_f32_16x16x32_bf16 v[224:227], v[252:255], v[68:71], v[224:227]
    v_fma_f32 v186, v186, v219, v222
    v_fma_f32 v187, v187, v219, v222
    v_fma_f32 v188, v188, v219, v222
    v_fma_f32 v189, v189, v219, v222
    v_fma_f32 v190, v190, v219, v222
    v_fma_f32 v191, v191, v219, v222
    v_fma_f32 v192, v192, v219, v222
    v_fma_f32 v193, v193, v219, v222
    v_fma_f32 v194, v194, v219, v222
    v_fma_f32 v195, v195, v219, v222
    v_fma_f32 v196, v196, v219, v222
    v_fma_f32 v197, v197, v219, v222
    v_fma_f32 v198, v198, v219, v222
    v_fma_f32 v199, v199, v219, v222
    v_mul_f32 v228, v120, v120
    v_mul_f32 v229, v121, v121
    v_cvt_pk_bf16_f32 v80, v184, v185
    v_cvt_pk_bf16_f32 v81, v186, v187
    v_cvt_pk_bf16_f32 v82, v188, v189
    v_cvt_pk_bf16_f32 v83, v190, v191
    v_cvt_pk_bf16_f32 v84, v192, v193
    v_cvt_pk_bf16_f32 v85, v194, v195
    v_cvt_pk_bf16_f32 v86, v196, v197
    v_cvt_pk_bf16_f32 v87, v198, v199
    v_mfma_f32_32x32x16_bf16 v[184:199], v[232:235], v[72:75], 0
    v_fmac_f32 v228, v122, v122
    v_fmac_f32 v229, v123, v123
    v_fmac_f32 v228, v124, v124
    v_fmac_f32 v229, v125, v125
    v_fmac_f32 v228, v126, v126
    v_fmac_f32 v229, v127, v127
    v_fma_f32 v176, v176, v219, v222
    v_fma_f32 v177, v177, v219, v222
    v_fma_f32 v178, v178, v219, v222
    v_fma_f32 v179, v179, v219, v222
    v_fma_f32 v180, v180, v219, v222
    v_fma_f32 v181, v181, v219, v222
    v_fma_f32 v182, v182, v219, v222
    v_fma_f32 v183, v183, v219, v222
    v_fmac_f32 v228, v128, v128
    v_fmac_f32 v229, v129, v129
    v_cvt_pk_bf16_f32 v76, v176, v177
    v_cvt_pk_bf16_f32 v77, v178, v179
    v_cvt_pk_bf16_f32 v78, v180, v181
    v_cvt_pk_bf16_f32 v79, v182, v183
    v_fmac_f32 v228, v130, v130
    v_fmac_f32 v229, v131, v131
    v_mfma_f32_32x32x16_bf16 v[184:199], v[236:239], v[76:79], v[184:199]
    v_fmac_f32 v228, v132, v132
    v_fmac_f32 v229, v133, v133
    v_fmac_f32 v228, v134, v134
    v_fmac_f32 v229, v135, v135
    v_fmac_f32 v228, v136, v136
    v_fmac_f32 v229, v137, v137
    v_mfma_f32_32x32x16_bf16 v[184:199], v[240:243], v[80:83], v[184:199]
    ds_read_b128 v[236:239], v6 offset:6144
    v_fmac_f32 v228, v138, v138
    v_fmac_f32 v229, v139, v139
    v_fmac_f32 v228, v140, v140
    v_fmac_f32 v229, v141, v141
    v_fmac_f32 v228, v142, v142
    v_mfma_f32_32x32x16_bf16 v[184:199], v[244:247], v[84:87], v[184:199]
    v_fmac_f32 v229, v143, v143
    ds_read_b128 v[232:235], v6 offset:5120
    v_fmac_f32 v228, v144, v144
    v_fmac_f32 v229, v145, v145
    v_fmac_f32 v228, v146, v146
    v_fmac_f32 v229, v147, v147
    ds_read_b128 v[240:243], v6 offset:7168
    v_fmac_f32 v228, v148, v148
    v_fmac_f32 v229, v149, v149
    v_fmac_f32 v228, v150, v150
    v_fmac_f32 v229, v151, v151
    v_fmac_f32 v228, v152, v152
    v_fmac_f32 v229, v153, v153
    v_fmac_f32 v228, v154, v154
    v_fmac_f32 v229, v155, v155
    v_fmac_f32 v228, v156, v156
    v_fmac_f32 v229, v157, v157
    ds_read_b128 v[244:247], v6 offset:8192
    v_fma_f32 v200, v200, v219, v222
    v_fma_f32 v201, v201, v219, v222
    v_fma_f32 v202, v202, v219, v222
    v_fma_f32 v203, v203, v219, v222
    v_fma_f32 v204, v204, v219, v222
    v_fma_f32 v205, v205, v219, v222
    v_fma_f32 v206, v206, v219, v222
    v_fma_f32 v207, v207, v219, v222
    v_fmac_f32 v228, v158, v158
    v_fmac_f32 v229, v159, v159
    v_cvt_pk_bf16_f32 v88, v200, v201
    v_cvt_pk_bf16_f32 v89, v202, v203
    v_cvt_pk_bf16_f32 v90, v204, v205
    v_cvt_pk_bf16_f32 v91, v206, v207
    v_fmac_f32 v228, v160, v160
    v_fmac_f32 v229, v161, v161
    v_mfma_f32_32x32x16_bf16 v[184:199], v[248:251], v[88:91], v[184:199]
    v_fmac_f32 v228, v162, v162
    v_fmac_f32 v229, v163, v163
    v_fma_f32 v208, v208, v219, v222
    v_fma_f32 v209, v209, v219, v222
    v_fma_f32 v210, v210, v219, v222
    v_fma_f32 v211, v211, v219, v222
    v_fma_f32 v212, v212, v219, v222
    v_fma_f32 v213, v213, v219, v222
    v_fma_f32 v214, v214, v219, v222
    v_fma_f32 v215, v215, v219, v222
    v_fmac_f32 v228, v164, v164
    v_fmac_f32 v229, v165, v165
    v_cvt_pk_bf16_f32 v92, v208, v209
    v_cvt_pk_bf16_f32 v93, v210, v211
    v_cvt_pk_bf16_f32 v94, v212, v213
    v_cvt_pk_bf16_f32 v95, v214, v215
    s_waitcnt lgkmcnt(0)
    v_mfma_f32_32x32x16_bf16 v[200:215], v[236:239], v[72:75], 0
    v_fmac_f32 v228, v166, v166
    v_fmac_f32 v229, v167, v167
    ds_read_b128 v[248:251], v6 offset:9216
    v_add_f32 v228, v228, v229
    v_mov_b32 v229, v228
    v_mul_f32 v224, s29, v224
    v_mfma_f32_32x32x16_bf16 v[184:199], v[232:235], v[92:95], v[184:199]
    v_permlane32_swap_b32 v228, v229
    v_add_f32 v228, v228, v229
    ds_read_b128 v[232:235], v6 offset:10240
    v_mul_f32 v228, s29, v228
    v_fma_f32 v228, -v224, v224, v228
    v_max_f32 v228, 0, v228
    v_mfma_f32_32x32x16_bf16 v[200:215], v[240:243], v[76:79], v[200:215]
    ds_read_b128 v[240:243], v6 offset:12288
    v_cvt_pk_bf16_f32 v228, v228, v228
    v_lshlrev_b32 v228, 16, v228
    ds_read_b128 v[236:239], v6 offset:11264
    v_add_f32 v228, s30, v228
    v_cvt_pk_bf16_f32 v228, v228, v228
    v_mfma_f32_32x32x16_bf16 v[200:215], v[244:247], v[80:83], v[200:215]
    ds_read_b128 v[244:247], v6 offset:13312
    v_lshlrev_b32 v228, 16, v228
    v_sqrt_f32 v228, v228
    v_cvt_pk_bf16_f32 v224, v224, v224
    v_cvt_pk_bf16_f32 v228, v228, v228
    v_lshlrev_b32 v228, 16, v228
    v_rcp_f32 v227, v228
    s_waitcnt lgkmcnt(1)
    v_mfma_f32_32x32x16_bf16 v[200:215], v[248:251], v[84:87], v[200:215]
    ds_read_b128 v[248:251], v6 offset:14336
    v_lshlrev_b32 v224, 16, v224
    v_mul_f32 v230, -v224, v227
    v_fma_f32 v120, v120, v227, v230
    v_fma_f32 v121, v121, v227, v230
    v_fma_f32 v122, v122, v227, v230
    v_mfma_f32_32x32x16_bf16 v[200:215], v[232:235], v[88:91], v[200:215]
    v_fma_f32 v123, v123, v227, v230
    v_fma_f32 v124, v124, v227, v230
    v_fma_f32 v125, v125, v227, v230
    v_fma_f32 v126, v126, v227, v230
    v_fma_f32 v127, v127, v227, v230
    v_fma_f32 v128, v128, v227, v230
    v_mfma_f32_32x32x16_bf16 v[200:215], v[236:239], v[92:95], v[200:215]
    v_fma_f32 v129, v129, v227, v230
    v_fma_f32 v130, v130, v227, v230
    v_fma_f32 v131, v131, v227, v230
    v_fma_f32 v132, v132, v227, v230
    v_fma_f32 v133, v133, v227, v230
    v_fma_f32 v134, v134, v227, v230
    v_fma_f32 v135, v135, v227, v230
    v_fma_f32 v136, v136, v227, v230
    v_fma_f32 v137, v137, v227, v230
    v_fma_f32 v138, v138, v227, v230
    v_fma_f32 v139, v139, v227, v230
    v_fma_f32 v140, v140, v227, v230
    v_fma_f32 v141, v141, v227, v230
    v_fma_f32 v142, v142, v227, v230
    v_fma_f32 v143, v143, v227, v230
    v_fma_f32 v144, v144, v227, v230
    v_fma_f32 v145, v145, v227, v230
    v_fma_f32 v146, v146, v227, v230
    v_fma_f32 v147, v147, v227, v230
    v_fma_f32 v148, v148, v227, v230
    v_fma_f32 v149, v149, v227, v230
    v_fma_f32 v150, v150, v227, v230
    v_fma_f32 v151, v151, v227, v230
    v_fma_f32 v152, v152, v227, v230
    v_fma_f32 v153, v153, v227, v230
    v_fma_f32 v154, v154, v227, v230
    v_fma_f32 v155, v155, v227, v230
    v_fma_f32 v156, v156, v227, v230
    v_fma_f32 v157, v157, v227, v230
    v_fma_f32 v158, v158, v227, v230
    v_fma_f32 v159, v159, v227, v230
    v_fma_f32 v160, v160, v227, v230
    v_fma_f32 v161, v161, v227, v230
    v_fma_f32 v162, v162, v227, v230
    v_fma_f32 v163, v163, v227, v230
    v_fma_f32 v164, v164, v227, v230
    v_fma_f32 v165, v165, v227, v230
    v_fma_f32 v166, v166, v227, v230
    v_fma_f32 v167, v167, v227, v230
    v_mfma_f32_32x32x16_bf16 v[216:231], v[240:243], v[72:75], 0
    ds_read_b128 v[232:235], v6 offset:15360
    ds_read_b128 v[236:239], v6 offset:16384
    ds_read_b128 v[240:243], v6 offset:17408
    v_cvt_pk_bf16_f32 v96, v120, v121
    v_cvt_pk_bf16_f32 v97, v122, v123
    v_cvt_pk_bf16_f32 v98, v124, v125
    s_waitcnt lgkmcnt(3)
    v_mfma_f32_32x32x16_bf16 v[216:231], v[244:247], v[76:79], v[216:231]
    ds_read_b128 v[244:247], v6 offset:0
    v_cvt_pk_bf16_f32 v99, v126, v127
    v_cvt_pk_bf16_f32 v120, v184, v185
    v_cvt_pk_bf16_f32 v121, v186, v187
    v_cvt_pk_bf16_f32 v122, v188, v189
    v_cvt_pk_bf16_f32 v123, v190, v191
    v_mfma_f32_32x32x16_bf16 v[216:231], v[248:251], v[80:83], v[216:231]
    ds_read_b128 v[248:251], v6 offset:1024
    v_cvt_pk_bf16_f32 v124, v192, v193
    v_cvt_pk_bf16_f32 v125, v194, v195
    v_cvt_pk_bf16_f32 v126, v196, v197
    v_cvt_pk_bf16_f32 v127, v198, v199
    v_cvt_pk_bf16_f32 v100, v128, v129
    v_mfma_f32_32x32x16_bf16 v[168:183], v[72:75], v[120:123], 0
    v_cvt_pk_bf16_f32 v101, v130, v131
    v_cvt_pk_bf16_f32 v102, v132, v133
    v_cvt_pk_bf16_f32 v103, v134, v135
    v_cvt_pk_bf16_f32 v104, v136, v137
    v_cvt_pk_bf16_f32 v105, v138, v139
    v_cvt_pk_bf16_f32 v106, v140, v141
    s_waitcnt lgkmcnt(0)
    v_mfma_f32_32x32x16_bf16 v[216:231], v[232:235], v[84:87], v[216:231]
    ds_read_b128 v[232:235], v6 offset:2048
    v_cvt_pk_bf16_f32 v107, v142, v143
    v_cvt_pk_bf16_f32 v108, v144, v145
    v_cvt_pk_bf16_f32 v109, v146, v147
    v_cvt_pk_bf16_f32 v110, v148, v149
    v_cvt_pk_bf16_f32 v111, v150, v151
    v_mfma_f32_32x32x16_bf16 v[216:231], v[236:239], v[88:91], v[216:231]
    ds_read_b128 v[236:239], v6 offset:3072
    v_cvt_pk_bf16_f32 v112, v152, v153
    v_cvt_pk_bf16_f32 v113, v154, v155
    v_cvt_pk_bf16_f32 v114, v156, v157
    v_cvt_pk_bf16_f32 v115, v158, v159
    v_cvt_pk_bf16_f32 v128, v200, v201
    v_mfma_f32_32x32x16_bf16 v[184:199], v[244:247], v[96:99], 0
    ds_read_b128 v[244:247], v6 offset:5120
    v_cvt_pk_bf16_f32 v129, v202, v203
    v_cvt_pk_bf16_f32 v130, v204, v205
    v_cvt_pk_bf16_f32 v131, v206, v207
    v_cvt_pk_bf16_f32 v132, v208, v209
    v_cvt_pk_bf16_f32 v133, v210, v211
    v_mfma_f32_32x32x16_bf16 v[216:231], v[240:243], v[92:95], v[216:231]
    ds_read_b128 v[240:243], v6 offset:4096
    v_cvt_pk_bf16_f32 v134, v212, v213
    v_cvt_pk_bf16_f32 v135, v214, v215
    v_cvt_pk_bf16_f32 v116, v160, v161
    v_cvt_pk_bf16_f32 v117, v162, v163
    v_cvt_pk_bf16_f32 v118, v164, v165
    v_mfma_f32_32x32x16_bf16 v[184:199], v[248:251], v[100:103], v[184:199]
    ds_read_b128 v[248:251], v6 offset:6144
    v_cvt_pk_bf16_f32 v119, v166, v167
    s_mov_b64 exec, 1
    ds_add_u32 v8, v9 offset:4
    s_mov_b64 exec, -1
    s_waitcnt lgkmcnt(3)
    v_mfma_f32_32x32x16_bf16 v[184:199], v[232:235], v[104:107], v[184:199]
    ds_read_b128 v[232:235], v6 offset:7168
    v_cvt_pk_bf16_f32 v136, v216, v217
    v_cvt_pk_bf16_f32 v137, v218, v219
    v_cvt_pk_bf16_f32 v138, v220, v221
    v_cvt_pk_bf16_f32 v139, v222, v223
    v_cvt_pk_bf16_f32 v140, v224, v225
    v_mfma_f32_32x32x16_bf16 v[184:199], v[236:239], v[108:111], v[184:199]
    ds_read_b128 v[236:239], v6 offset:8192
    v_cvt_pk_bf16_f32 v141, v226, v227
    v_cvt_pk_bf16_f32 v142, v228, v229
    v_cvt_pk_bf16_f32 v143, v230, v231
    s_waitcnt lgkmcnt(1)
    v_mfma_f32_32x32x16_bf16 v[184:199], v[240:243], v[112:115], v[184:199]
    ds_read_b128 v[240:243], v6 offset:9216
    v_mfma_f32_32x32x16_bf16 v[200:215], v[248:251], v[96:99], 0
    ds_read_b128 v[248:251], v6 offset:11264
    v_mfma_f32_32x32x16_bf16 v[184:199], v[244:247], v[116:119], v[184:199]
    ds_read_b128 v[244:247], v6 offset:10240
    v_mfma_f32_32x32x16_bf16 v[200:215], v[232:235], v[100:103], v[200:215]
    ds_read_b128 v[232:235], v6 offset:12288
    s_waitcnt lgkmcnt(4)
    v_mfma_f32_32x32x16_bf16 v[200:215], v[236:239], v[104:107], v[200:215]
    ds_read_b128 v[236:239], v6 offset:13312
    s_nop 5
    v_cvt_pk_bf16_f32 v144, v184, v185
    v_cvt_pk_bf16_f32 v145, v186, v187
    v_cvt_pk_bf16_f32 v146, v188, v189
    v_cvt_pk_bf16_f32 v147, v190, v191
    v_cvt_pk_bf16_f32 v148, v192, v193
    s_waitcnt lgkmcnt(2)
    v_mfma_f32_32x32x16_bf16 v[200:215], v[240:243], v[108:111], v[200:215]
    ds_read_b128 v[240:243], v6 offset:14336
    v_cvt_pk_bf16_f32 v149, v194, v195
    v_cvt_pk_bf16_f32 v150, v196, v197
    v_cvt_pk_bf16_f32 v151, v198, v199
    v_mfma_f32_32x32x16_bf16 v[200:215], v[244:247], v[112:115], v[200:215]
    ds_read_b128 v[244:247], v6 offset:15360
    s_waitcnt lgkmcnt(2)
    v_mfma_f32_32x32x16_bf16 v[216:231], v[232:235], v[96:99], 0
    ds_read_b128 v[232:235], v6 offset:17408
    v_mfma_f32_32x32x16_bf16 v[200:215], v[248:251], v[116:119], v[200:215]
    ds_read_b128 v[248:251], v6 offset:16384
    v_mfma_f32_32x32x16_bf16 v[216:231], v[236:239], v[100:103], v[216:231]
    ds_read_b128 v[236:239], v6 offset:18432
    s_waitcnt lgkmcnt(4)
    v_mfma_f32_32x32x16_bf16 v[216:231], v[240:243], v[104:107], v[216:231]
    ds_read_b128 v[240:243], v6 offset:19456
    s_nop 5
    v_cvt_pk_bf16_f32 v152, v200, v201
    v_cvt_pk_bf16_f32 v153, v202, v203
    v_cvt_pk_bf16_f32 v154, v204, v205
    v_cvt_pk_bf16_f32 v155, v206, v207
    v_cvt_pk_bf16_f32 v156, v208, v209
    s_waitcnt lgkmcnt(2)
    v_mfma_f32_32x32x16_bf16 v[216:231], v[244:247], v[108:111], v[216:231]
    ds_read_b128 v[244:247], v6 offset:20480
    v_cvt_pk_bf16_f32 v157, v210, v211
    v_cvt_pk_bf16_f32 v158, v212, v213
    v_cvt_pk_bf16_f32 v159, v214, v215
    v_mfma_f32_32x32x16_bf16 v[216:231], v[248:251], v[112:115], v[216:231]
    ds_read_b128 v[248:251], v6 offset:21504
    v_mfma_f32_32x32x16_bf16 v[216:231], v[232:235], v[116:119], v[216:231]
    ds_read_b128 v[232:235], v6 offset:22528
    s_waitcnt lgkmcnt(3)
    v_mfma_f32_32x32x16_bf16 v[184:199], v[72:75], v[236:239], 0
    v_mfma_f32_32x32x16_bf16 v[184:199], v[76:79], v[240:243], v[184:199]
    s_nop 7
    v_cvt_pk_bf16_f32 v160, v216, v217
    v_cvt_pk_bf16_f32 v161, v218, v219
    v_cvt_pk_bf16_f32 v162, v220, v221
    v_cvt_pk_bf16_f32 v163, v222, v223
    v_cvt_pk_bf16_f32 v164, v224, v225
    v_cvt_pk_bf16_f32 v165, v226, v227
    v_mfma_f32_32x32x16_bf16 v[200:215], v[96:99], v[144:147], 0
    v_cvt_pk_bf16_f32 v166, v228, v229
    v_cvt_pk_bf16_f32 v167, v230, v231
    v_mfma_f32_32x32x16_bf16 v[216:231], v[96:99], v[236:239], 0
    ds_read_b128 v[236:239], v6 offset:23552
    v_mfma_f32_32x32x16_bf16 v[216:231], v[100:103], v[240:243], v[216:231]
    ds_read_b128 v[240:243], v6 offset:24576
    s_waitcnt lgkmcnt(2)
    v_mfma_f32_32x32x16_bf16 v[184:199], v[80:83], v[244:247], v[184:199]
    v_mfma_f32_32x32x16_bf16 v[216:231], v[104:107], v[244:247], v[216:231]
    ds_read_b128 v[244:247], v6 offset:25600
    v_mfma_f32_32x32x16_bf16 v[200:215], v[100:103], v[148:151], v[200:215]
    v_mfma_f32_32x32x16_bf16 v[168:183], v[76:79], v[124:127], v[168:183]
    v_mfma_f32_32x32x16_bf16 v[184:199], v[84:87], v[248:251], v[184:199]
    v_mfma_f32_32x32x16_bf16 v[216:231], v[108:111], v[248:251], v[216:231]
    ds_read_b128 v[248:251], v6 offset:26624
    v_mfma_f32_32x32x16_bf16 v[200:215], v[104:107], v[152:155], v[200:215]
    v_mfma_f32_32x32x16_bf16 v[168:183], v[80:83], v[128:131], v[168:183]
    v_lshlrev_b32 v128, 16, v28
    v_and_b32 v129, s31, v28
    v_lshlrev_b32 v130, 16, v29
    v_and_b32 v131, s31, v29
    v_mfma_f32_32x32x16_bf16 v[184:199], v[88:91], v[232:235], v[184:199]
    v_mfma_f32_32x32x16_bf16 v[216:231], v[112:115], v[232:235], v[216:231]
    ds_read_b128 v[232:235], v6 offset:27648
    v_mfma_f32_32x32x16_bf16 v[200:215], v[108:111], v[156:159], v[200:215]
    v_mfma_f32_32x32x16_bf16 v[168:183], v[84:87], v[132:135], v[168:183]
    v_lshlrev_b32 v132, 16, v30
    v_and_b32 v133, s31, v30
    v_lshlrev_b32 v134, 16, v31
    v_and_b32 v135, s31, v31
    s_waitcnt lgkmcnt(1)
    v_mfma_f32_32x32x16_bf16 v[184:199], v[92:95], v[236:239], v[184:199]
    v_mfma_f32_32x32x16_bf16 v[216:231], v[116:119], v[236:239], v[216:231]
    ds_read_b128 v[236:239], v6 offset:28672
    v_mfma_f32_32x32x16_bf16 v[200:215], v[112:115], v[160:163], v[200:215]
    s_nop 8
    v_cvt_pk_bf16_f32 v152, v184, v185
    v_cvt_pk_bf16_f32 v153, v186, v187
    v_cvt_pk_bf16_f32 v154, v188, v189
    v_cvt_pk_bf16_f32 v155, v190, v191
    v_cvt_pk_bf16_f32 v156, v192, v193
    v_cvt_pk_bf16_f32 v157, v194, v195
    v_mfma_f32_32x32x16_bf16 v[168:183], v[88:91], v[136:139], v[168:183]
    v_cvt_pk_bf16_f32 v158, v196, v197
    v_cvt_pk_bf16_f32 v159, v198, v199
    v_cvt_pk_bf16_f32 v160, v216, v217
    v_cvt_pk_bf16_f32 v161, v218, v219
    v_cvt_pk_bf16_f32 v162, v220, v221
    v_cvt_pk_bf16_f32 v163, v222, v223
    v_mfma_f32_32x32x16_bf16 v[200:215], v[116:119], v[164:167], v[200:215]
    v_cvt_pk_bf16_f32 v164, v224, v225
    v_cvt_pk_bf16_f32 v165, v226, v227
    v_cvt_pk_bf16_f32 v166, v228, v229
    v_cvt_pk_bf16_f32 v167, v230, v231
    v_lshlrev_b32 v136, 16, v48
    v_and_b32 v137, s31, v48
    v_mfma_f32_32x32x16_bf16 v[168:183], v[92:95], v[140:143], v[168:183]
    v_lshlrev_b32 v138, 16, v49
    v_and_b32 v139, s31, v49
    v_lshlrev_b32 v140, 16, v50
    v_and_b32 v141, s31, v50
    v_lshlrev_b32 v142, 16, v51
    v_and_b32 v143, s31, v51
    v_mfma_f32_32x32x16_bf16 v[184:199], v[72:75], v[240:243], 0
    v_cndmask_b32 v144, v200, v204, s[18:19]
    v_cndmask_b32 v145, v201, v205, s[18:19]
    v_cndmask_b32 v146, v202, v206, s[18:19]
    v_cndmask_b32 v144, v144, v208, s[20:21]
    v_cndmask_b32 v145, v145, v209, s[20:21]
    v_cndmask_b32 v146, v146, v210, s[20:21]
    v_mfma_f32_32x32x16_bf16 v[216:231], v[96:99], v[240:243], 0
    v_cndmask_b32 v120, v168, v172, s[18:19]
    v_cndmask_b32 v121, v169, v173, s[18:19]
    v_cndmask_b32 v122, v170, v174, s[18:19]
    v_cndmask_b32 v120, v120, v176, s[20:21]
    v_cndmask_b32 v121, v121, v177, s[20:21]
    v_cndmask_b32 v122, v122, v178, s[20:21]
    v_mfma_f32_32x32x16_bf16 v[184:199], v[76:79], v[244:247], v[184:199]
    v_cndmask_b32 v123, v171, v175, s[18:19]
    v_cndmask_b32 v147, v203, v207, s[18:19]
    ds_read_b128 v[240:243], v6 offset:29696
    v_cndmask_b32 v120, v120, v180, s[22:23]
    v_cndmask_b32 v121, v121, v181, s[22:23]
    v_cndmask_b32 v122, v122, v182, s[22:23]
    v_mfma_f32_32x32x16_bf16 v[216:231], v[100:103], v[244:247], v[216:231]
    v_cndmask_b32 v123, v123, v179, s[20:21]
    v_cndmask_b32 v144, v144, v212, s[22:23]
    v_cndmask_b32 v145, v145, v213, s[22:23]
    v_cndmask_b32 v146, v146, v214, s[22:23]
    v_cndmask_b32 v147, v147, v211, s[20:21]
    v_cndmask_b32 v123, v123, v183, s[22:23]
    v_mfma_f32_32x32x16_bf16 v[184:199], v[80:83], v[248:251], v[184:199]
    v_max3_f32 v124, v120, v121, v122
    v_cndmask_b32 v147, v147, v215, s[22:23]
    v_max3_f32 v148, v144, v145, v146
    v_max_f32 v124, v124, v123
    v_max_f32 v148, v148, v147
    v_mul_f32 v124, s28, v124
    v_mfma_f32_32x32x16_bf16 v[216:231], v[104:107], v[248:251], v[216:231]
    v_mul_f32 v148, s28, v148
    v_fma_f32 v120, v120, s28, -v124
    v_fma_f32 v121, v121, s28, -v124
    v_fma_f32 v122, v122, s28, -v124
    v_fma_f32 v123, v123, s28, -v124
    v_fma_f32 v144, v144, s28, -v148
    s_waitcnt lgkmcnt(0)
    v_mfma_f32_32x32x16_bf16 v[184:199], v[84:87], v[232:235], v[184:199]
    v_fma_f32 v145, v145, s28, -v148
    v_fma_f32 v146, v146, s28, -v148
    v_fma_f32 v147, v147, s28, -v148
    v_exp_f32 v120, v120
    v_exp_f32 v121, v121
    v_mfma_f32_32x32x16_bf16 v[216:231], v[108:111], v[232:235], v[216:231]
    v_exp_f32 v122, v122
    v_exp_f32 v123, v123
    v_exp_f32 v144, v144
    v_mfma_f32_32x32x16_bf16 v[184:199], v[88:91], v[236:239], v[184:199]
    v_exp_f32 v145, v145
    v_exp_f32 v146, v146
    v_exp_f32 v147, v147
    v_mfma_f32_32x32x16_bf16 v[216:231], v[112:115], v[236:239], v[216:231]
    v_add_f32 v125, v120, v121
    v_add_f32 v124, v122, v123
    v_add_f32 v149, v144, v145
    v_add_f32 v148, v146, v147
    v_add_f32 v125, v125, v124
    v_add_f32 v149, v149, v148
    v_mfma_f32_32x32x16_bf16 v[184:199], v[92:95], v[240:243], v[184:199]
    v_rcp_f32 v125, v125
    v_rcp_f32 v149, v149
    ds_read_b128 v[244:247], v6 offset:30720
    v_cndmask_b32 v125, 0, v125, s[24:25]
    v_mfma_f32_32x32x16_bf16 v[216:231], v[116:119], v[240:243], v[216:231]
    v_cndmask_b32 v149, 0, v149, s[24:25]
    v_mul_f32 v120, v120, v125
    v_mul_f32 v121, v121, v125
    v_mul_f32 v122, v122, v125
    v_mul_f32 v123, v123, v125
    v_mul_f32 v144, v144, v149
    v_mul_f32 v145, v145, v149
    v_mul_f32 v146, v146, v149
    v_mul_f32 v147, v147, v149
    v_cvt_pk_bf16_f32 v126, v120, v121
    v_cvt_pk_bf16_f32 v127, v122, v123
    v_cvt_pk_bf16_f32 v150, v144, v145
    v_cvt_pk_bf16_f32 v151, v146, v147
    v_cndmask_b32 v168, 0, v126, s[16:17]
    v_cndmask_b32 v169, 0, v127, s[16:17]
    v_cndmask_b32 v170, 0, v126, s[18:19]
    v_cndmask_b32 v171, 0, v127, s[18:19]
    v_cndmask_b32 v172, 0, v126, s[20:21]
    v_cndmask_b32 v173, 0, v127, s[20:21]
    v_cndmask_b32 v174, 0, v126, s[22:23]
    v_cndmask_b32 v175, 0, v127, s[22:23]
    v_cndmask_b32 v200, 0, v150, s[16:17]
    v_cndmask_b32 v201, 0, v151, s[16:17]
    v_cndmask_b32 v202, 0, v150, s[18:19]
    v_cndmask_b32 v203, 0, v151, s[18:19]
    v_cndmask_b32 v204, 0, v150, s[20:21]
    v_cndmask_b32 v205, 0, v151, s[20:21]
    v_cndmask_b32 v206, 0, v150, s[22:23]
    v_cndmask_b32 v207, 0, v151, s[22:23]
    ds_read_b128 v[248:251], v6 offset:31744
    v_lshlrev_b32 v120, 16, v24
    v_and_b32 v121, s31, v24
    v_lshlrev_b32 v122, 16, v25
    v_and_b32 v123, s31, v25
    v_lshlrev_b32 v124, 16, v26
    v_and_b32 v125, s31, v26
    v_lshlrev_b32 v126, 16, v27
    v_and_b32 v127, s31, v27
    v_lshlrev_b32 v144, 16, v52
    v_and_b32 v145, s31, v52
    v_mfma_f32_32x32x16_bf16 v[120:135], v[152:155], v[168:171], v[120:135]
    v_lshlrev_b32 v146, 16, v53
    v_and_b32 v147, s31, v53
    v_lshlrev_b32 v148, 16, v54
    v_and_b32 v149, s31, v54
    v_lshlrev_b32 v150, 16, v55
    v_and_b32 v151, s31, v55
    v_mfma_f32_32x32x16_bf16 v[120:135], v[156:159], v[172:175], v[120:135]
    ds_read_b128 v[232:235], v6 offset:32768
    v_cvt_pk_bf16_f32 v152, v184, v185
    v_cvt_pk_bf16_f32 v153, v186, v187
    v_cvt_pk_bf16_f32 v154, v188, v189
    v_cvt_pk_bf16_f32 v155, v190, v191
    v_cvt_pk_bf16_f32 v156, v192, v193
    v_mfma_f32_32x32x16_bf16 v[136:151], v[160:163], v[200:203], v[136:151]
    v_cvt_pk_bf16_f32 v157, v194, v195
    v_cvt_pk_bf16_f32 v158, v196, v197
    v_cvt_pk_bf16_f32 v159, v198, v199
    v_cvt_pk_bf16_f32 v160, v216, v217
    v_cvt_pk_bf16_f32 v161, v218, v219
    v_cvt_pk_bf16_f32 v162, v220, v221
    v_mfma_f32_32x32x16_bf16 v[136:151], v[164:167], v[204:207], v[136:151]
    v_cvt_pk_bf16_f32 v163, v222, v223
    v_cvt_pk_bf16_f32 v164, v224, v225
    v_cvt_pk_bf16_f32 v165, v226, v227
    v_cvt_pk_bf16_f32 v166, v228, v229
    v_cvt_pk_bf16_f32 v167, v230, v231
    ds_read_b128 v[236:239], v6 offset:33792
    s_waitcnt lgkmcnt(1)
    v_mfma_f32_32x32x16_bf16 v[184:199], v[72:75], v[244:247], 0
    ds_read_b128 v[240:243], v6 offset:34816
    v_cvt_pk_bf16_f32 v24, v120, v121
    v_cvt_pk_bf16_f32 v25, v122, v123
    v_cvt_pk_bf16_f32 v26, v124, v125
    v_cvt_pk_bf16_f32 v27, v126, v127
    v_cvt_pk_bf16_f32 v28, v128, v129
    v_mfma_f32_32x32x16_bf16 v[216:231], v[96:99], v[244:247], 0
    ds_read_b128 v[244:247], v6 offset:35840
    v_cvt_pk_bf16_f32 v29, v130, v131
    v_cvt_pk_bf16_f32 v30, v132, v133
    v_cvt_pk_bf16_f32 v31, v134, v135
    v_cvt_pk_bf16_f32 v48, v136, v137
    v_cvt_pk_bf16_f32 v49, v138, v139
    v_mfma_f32_32x32x16_bf16 v[184:199], v[76:79], v[248:251], v[184:199]
    v_cvt_pk_bf16_f32 v50, v140, v141
    v_cvt_pk_bf16_f32 v51, v142, v143
    v_cvt_pk_bf16_f32 v52, v144, v145
    v_cvt_pk_bf16_f32 v53, v146, v147
    v_cvt_pk_bf16_f32 v54, v148, v149
    v_cvt_pk_bf16_f32 v55, v150, v151
    v_mfma_f32_32x32x16_bf16 v[216:231], v[100:103], v[248:251], v[216:231]
    v_lshlrev_b32 v120, 16, v32
    v_and_b32 v121, s31, v32
    v_lshlrev_b32 v122, 16, v33
    v_and_b32 v123, s31, v33
    v_lshlrev_b32 v124, 16, v34
    v_and_b32 v125, s31, v34
    v_mfma_f32_32x32x16_bf16 v[184:199], v[80:83], v[232:235], v[184:199]
    v_lshlrev_b32 v126, 16, v35
    v_and_b32 v127, s31, v35
    v_lshlrev_b32 v128, 16, v36
    v_and_b32 v129, s31, v36
    v_lshlrev_b32 v130, 16, v37
    v_and_b32 v131, s31, v37
    v_mfma_f32_32x32x16_bf16 v[216:231], v[104:107], v[232:235], v[216:231]
    v_lshlrev_b32 v132, 16, v38
    v_and_b32 v133, s31, v38
    v_lshlrev_b32 v134, 16, v39
    v_and_b32 v135, s31, v39
    v_lshlrev_b32 v136, 16, v56
    v_and_b32 v137, s31, v56
    s_waitcnt lgkmcnt(0)
    v_mfma_f32_32x32x16_bf16 v[184:199], v[84:87], v[236:239], v[184:199]
    v_lshlrev_b32 v138, 16, v57
    v_and_b32 v139, s31, v57
    v_lshlrev_b32 v140, 16, v58
    v_and_b32 v141, s31, v58
    v_lshlrev_b32 v142, 16, v59
    v_and_b32 v143, s31, v59
    v_mfma_f32_32x32x16_bf16 v[216:231], v[108:111], v[236:239], v[216:231]
    v_lshlrev_b32 v144, 16, v60
    v_and_b32 v145, s31, v60
    v_lshlrev_b32 v146, 16, v61
    v_and_b32 v147, s31, v61
    v_lshlrev_b32 v148, 16, v62
    v_and_b32 v149, s31, v62
    v_mfma_f32_32x32x16_bf16 v[120:135], v[152:155], v[168:171], v[120:135]
    v_lshlrev_b32 v150, 16, v63
    v_and_b32 v151, s31, v63
    s_nop 1
    v_mfma_f32_32x32x16_bf16 v[136:151], v[160:163], v[200:203], v[136:151]
    v_mfma_f32_32x32x16_bf16 v[184:199], v[88:91], v[240:243], v[184:199]
    v_mfma_f32_32x32x16_bf16 v[216:231], v[112:115], v[240:243], v[216:231]
    v_mfma_f32_32x32x16_bf16 v[120:135], v[156:159], v[172:175], v[120:135]
    v_mfma_f32_32x32x16_bf16 v[136:151], v[164:167], v[204:207], v[136:151]
    v_mfma_f32_32x32x16_bf16 v[184:199], v[92:95], v[244:247], v[184:199]
    s_nop 9
    v_cvt_pk_bf16_f32 v32, v120, v121
    v_cvt_pk_bf16_f32 v33, v122, v123
    v_cvt_pk_bf16_f32 v34, v124, v125
    v_cvt_pk_bf16_f32 v35, v126, v127
    v_cvt_pk_bf16_f32 v36, v128, v129
    v_cvt_pk_bf16_f32 v37, v130, v131
    v_mfma_f32_32x32x16_bf16 v[216:231], v[116:119], v[244:247], v[216:231]
    v_cvt_pk_bf16_f32 v38, v132, v133
    v_cvt_pk_bf16_f32 v39, v134, v135
    v_cvt_pk_bf16_f32 v56, v136, v137
    v_cvt_pk_bf16_f32 v57, v138, v139
    v_cvt_pk_bf16_f32 v58, v140, v141
    v_cvt_pk_bf16_f32 v59, v142, v143
    v_cvt_pk_bf16_f32 v60, v144, v145
    v_cvt_pk_bf16_f32 v61, v146, v147
    v_cvt_pk_bf16_f32 v62, v148, v149
    v_cvt_pk_bf16_f32 v63, v150, v151
    v_cvt_pk_bf16_f32 v152, v184, v185
    v_cvt_pk_bf16_f32 v153, v186, v187
    v_cvt_pk_bf16_f32 v154, v188, v189
    v_cvt_pk_bf16_f32 v155, v190, v191
    v_lshlrev_b32 v120, 16, v40
    v_and_b32 v121, s31, v40
    v_cvt_pk_bf16_f32 v160, v216, v217
    v_cvt_pk_bf16_f32 v161, v218, v219
    v_cvt_pk_bf16_f32 v162, v220, v221
    v_cvt_pk_bf16_f32 v163, v222, v223
    v_lshlrev_b32 v122, 16, v41
    v_and_b32 v123, s31, v41
    v_lshlrev_b32 v124, 16, v42
    v_and_b32 v125, s31, v42
    v_lshlrev_b32 v126, 16, v43
    v_and_b32 v127, s31, v43
    v_lshlrev_b32 v128, 16, v44
    v_and_b32 v129, s31, v44
    v_lshlrev_b32 v130, 16, v45
    v_and_b32 v131, s31, v45
    v_lshlrev_b32 v132, 16, v46
    v_and_b32 v133, s31, v46
    v_lshlrev_b32 v134, 16, v47
    v_and_b32 v135, s31, v47
    v_lshlrev_b32 v136, 16, v64
    v_and_b32 v137, s31, v64
    v_mfma_f32_32x32x16_bf16 v[120:135], v[152:155], v[168:171], v[120:135]
    v_lshlrev_b32 v138, 16, v65
    v_and_b32 v139, s31, v65
    v_lshlrev_b32 v140, 16, v66
    v_and_b32 v141, s31, v66
    v_lshlrev_b32 v142, 16, v67
    v_and_b32 v143, s31, v67
    v_lshlrev_b32 v144, 16, v68
    v_and_b32 v145, s31, v68
    v_lshlrev_b32 v146, 16, v69
    v_and_b32 v147, s31, v69
    v_lshlrev_b32 v148, 16, v70
    v_and_b32 v149, s31, v70
    v_lshlrev_b32 v150, 16, v71
    v_and_b32 v151, s31, v71
    v_cvt_pk_bf16_f32 v156, v192, v193
    v_cvt_pk_bf16_f32 v157, v194, v195
    v_mfma_f32_32x32x16_bf16 v[136:151], v[160:163], v[200:203], v[136:151]
    v_cvt_pk_bf16_f32 v158, v196, v197
    v_cvt_pk_bf16_f32 v159, v198, v199
    v_cvt_pk_bf16_f32 v164, v224, v225
    v_cvt_pk_bf16_f32 v165, v226, v227
    v_cvt_pk_bf16_f32 v166, v228, v229
    v_cvt_pk_bf16_f32 v167, v230, v231
    v_mfma_f32_32x32x16_bf16 v[120:135], v[156:159], v[172:175], v[120:135]
    s_nop 0
    v_mfma_f32_32x32x16_bf16 v[136:151], v[164:167], v[204:207], v[136:151]
    s_nop 9
    v_cvt_pk_bf16_f32 v40, v120, v121
    v_cvt_pk_bf16_f32 v41, v122, v123
    v_cvt_pk_bf16_f32 v42, v124, v125
    v_cvt_pk_bf16_f32 v43, v126, v127
    v_cvt_pk_bf16_f32 v44, v128, v129
    v_cvt_pk_bf16_f32 v45, v130, v131
    v_cvt_pk_bf16_f32 v46, v132, v133
    v_cvt_pk_bf16_f32 v47, v134, v135
    v_cvt_pk_bf16_f32 v64, v136, v137
    v_cvt_pk_bf16_f32 v65, v138, v139
    v_cvt_pk_bf16_f32 v66, v140, v141
    v_cvt_pk_bf16_f32 v67, v142, v143
    v_cvt_pk_bf16_f32 v68, v144, v145
    v_cvt_pk_bf16_f32 v69, v146, v147
    v_cvt_pk_bf16_f32 v70, v148, v149
    v_cvt_pk_bf16_f32 v71, v150, v151
    s_nop 12
    s_waitcnt lgkmcnt(0)
    s_cmp_ge_u32 s96, 4096
    s_cbranch_scc1 L_tonly
L_spinR:
    ds_read_b32 v10, v8 offset:4
    s_waitcnt lgkmcnt(0)
    v_readfirstlane_b32 s37, v10
    s_nop 3
    s_cmp_ge_u32 s37, s36
    s_cbranch_scc1 L_spinR_go
    s_sleep 1
    s_branch L_spinR
L_spinR_go:
    s_mov_b64 exec, s[26:27]
    ds_write_b128 v4, v[24:27] offset:0
    ds_write_b128 v4, v[28:31] offset:768
    ds_write_b128 v4, v[32:35] offset:1536
    ds_write_b128 v4, v[36:39] offset:2304
    ds_write_b128 v4, v[40:43] offset:3072
    ds_write_b128 v4, v[44:47] offset:3840
    ds_write_b128 v4, v[48:51] offset:4608
    ds_write_b128 v4, v[52:55] offset:5376
    ds_write_b128 v4, v[56:59] offset:6144
    ds_write_b128 v4, v[60:63] offset:6912
    ds_write_b128 v4, v[64:67] offset:7680
    ds_write_b128 v4, v[68:71] offset:8448
    s_mov_b64 exec, -1
    s_waitcnt lgkmcnt(0)
    s_mov_b64 exec, 1
    ds_add_u32 v8, v9 offset:0
    s_mov_b64 exec, -1
    s_add_u32 s97, s97, 4
    s_mul_i32 s38, s34, 9633792
    s_add_u32 s38, s38, s89
    s_add_u32 s52, s38, 0
    s_add_u32 s53, s38, 0
    s_add_u32 s54, s38, 86528
    s_add_u32 s55, s38, 172032
    s_add_u32 s56, s38, 172032
    s_add_u32 s57, s38, 258560
    s_add_u32 s58, s38, 43008
    s_add_u32 s59, s38, 43008
    s_add_u32 s60, s38, 129536
    s_add_u32 s61, s38, 215040
    s_add_u32 s62, s38, 215040
    s_add_u32 s63, s38, 301568
    s_and_b32 s86, s98, 0xfff
    s_mul_hi_u32 s37, s86, 153391690
    s_mul_i32 s38, s37, 28
    s_sub_u32 s38, s86, s38
    s_mul_i32 s37, s37, 344064
    s_mul_i32 s38, s38, 1536
    s_add_u32 s87, s37, s38
    s_cmp_ge_u32 s98, 12288
    s_cbranch_scc1 L_pfS0
L_pfX0:
    s_mov_b32 s76, s8
    s_mov_b32 s77, s9
    s_mov_b32 s78, s10
    s_mov_b32 s79, s11
    v_mov_b32 v1, v7
    s_mul_i32 s38, s34, 86016
    s_add_u32 s38, s38, s87
    s_add_u32 s40, s38, 0
    s_add_u32 s41, s38, 0
    s_add_u32 s42, s38, 9634304
    s_add_u32 s43, s38, 19267584
    s_add_u32 s44, s38, 19267584
    s_add_u32 s45, s38, 28901888
    s_add_u32 s46, s38, 43008
    s_add_u32 s47, s38, 43008
    s_add_u32 s48, s38, 9677312
    s_add_u32 s49, s38, 19310592
    s_add_u32 s50, s38, 19310592
    s_add_u32 s51, s38, 28944896
    s_branch L_pfE0
L_pfS0:
    s_mov_b32 s39, s87
    s_mov_b32 s87, 0x40000000
    s_cmp_ge_u32 s98, 61440
    s_cbranch_scc1 L_pfX0
    s_mov_b32 s87, s39
    s_sub_u32 s3, s86, 768
    s_and_b32 s37, s3, 0xfffc
    v_mov_b32 v14, s37
    s_and_b32 s3, s3, 3
    s_lshl_b32 s3, s3, 3
L_flag0:
    global_load_dword v15, v14, s[90:91] sc1
    s_waitcnt vmcnt(0)
    v_readfirstlane_b32 s37, v15
    s_nop 3
    s_lshr_b32 s37, s37, s3
    s_and_b32 s37, s37, 0xff
    s_cmp_ge_u32 s37, 4
    s_cbranch_scc1 L_flag_go0
    s_sleep 40
    s_branch L_flag0
L_flag_go0:
    s_mov_b32 s76, s4
    s_mov_b32 s77, s5
    s_mov_b32 s78, s6
    s_mov_b32 s79, s7
    v_mov_b32 v1, v11
    s_mul_i32 s38, s34, 9633792
    s_add_u32 s38, s38, s87
    s_add_u32 s40, s38, 0
    s_add_u32 s41, s38, 0
    s_add_u32 s42, s38, 86528
    s_add_u32 s43, s38, 172032
    s_add_u32 s44, s38, 172032
    s_add_u32 s45, s38, 258560
    s_add_u32 s46, s38, 43008
    s_add_u32 s47, s38, 43008
    s_add_u32 s48, s38, 129536
    s_add_u32 s49, s38, 215040
    s_add_u32 s50, s38, 215040
    s_add_u32 s51, s38, 301568
L_pfE0:
L_spinW:
    ds_read_b32 v10, v8 offset:0
    s_waitcnt lgkmcnt(0)
    v_readfirstlane_b32 s37, v10
    s_nop 3
    s_cmp_ge_u32 s37, s97
    s_cbranch_scc1 L_spinW_go
    s_sleep 1
    s_branch L_spinW
L_spinW_go:
    s_mov_b64 exec, s[26:27]
    ds_read_b128 v[24:27], v5 offset:0
    ds_read_b128 v[28:31], v5 offset:768
    ds_read_b128 v[32:35], v5 offset:1536
    ds_read_b128 v[36:39], v5 offset:2304
    ds_read_b128 v[40:43], v5 offset:3072
    ds_read_b128 v[44:47], v5 offset:3840
    ds_read_b128 v[48:51], v5 offset:4608
    ds_read_b128 v[52:55], v5 offset:5376
    ds_read_b128 v[56:59], v5 offset:6144
    ds_read_b128 v[60:63], v5 offset:6912
    ds_read_b128 v[64:67], v5 offset:7680
    ds_read_b128 v[68:71], v5 offset:8448
    s_mov_b64 exec, -1
L_S:
    s_waitcnt lgkmcnt(0)
    v_mov_b32 v14, 153632
L_pD:
    ds_read_b32 v10, v14 offset:16
    s_waitcnt lgkmcnt(0)
    v_readfirstlane_b32 s37, v10
    s_nop 3
    s_cmp_ge_u32 s37, s99
    s_cbranch_scc1 L_pD_go
    s_sleep 1
    s_branch L_pD
L_pD_go:
    v_mfma_f32_32x32x16_bf16 v[168:183], v[16:19], v[24:27], 0
    ds_read_b128 v[248:251], v0 offset:0
    ds_read_b128 v[232:235], v0 offset:1024
    ds_read_b128 v[236:239], v0 offset:2048
    ds_read_b128 v[240:243], v0 offset:3072
    ds_read_b128 v[244:247], v0 offset:4096
    v_mfma_f32_32x32x16_bf16 v[168:183], v[20:23], v[28:31], v[168:183]
    v_mfma_f32_32x32x16_bf16 v[184:199], v[16:19], v[32:35], 0
    v_mfma_f32_16x16x32_bf16 v[216:219], v[252:255], v[24:27], 0
    s_nop 9
    v_mul_f32 v220, v168, v168
    v_mul_f32 v221, v169, v169
    v_mfma_f32_32x32x16_bf16 v[184:199], v[20:23], v[36:39], v[184:199]
    v_fmac_f32 v220, v170, v170
    v_fmac_f32 v221, v171, v171
    v_fmac_f32 v220, v172, v172
    v_fmac_f32 v221, v173, v173
    v_fmac_f32 v220, v174, v174
    v_fmac_f32 v221, v175, v175
    v_mfma_f32_16x16x32_bf16 v[216:219], v[252:255], v[28:31], v[216:219]
    v_fmac_f32 v220, v176, v176
    v_fmac_f32 v221, v177, v177
    v_mfma_f32_32x32x16_bf16 v[200:215], v[16:19], v[40:43], 0
    v_fmac_f32 v220, v178, v178
    v_fmac_f32 v221, v179, v179
    v_fmac_f32 v220, v180, v180
    v_fmac_f32 v221, v181, v181
    v_fmac_f32 v220, v182, v182
    v_fmac_f32 v221, v183, v183
    v_mfma_f32_16x16x32_bf16 v[216:219], v[252:255], v[32:35], v[216:219]
    v_fmac_f32 v220, v184, v184
    v_fmac_f32 v221, v185, v185
    v_mfma_f32_32x32x16_bf16 v[200:215], v[20:23], v[44:47], v[200:215]
    v_fmac_f32 v220, v186, v186
    v_fmac_f32 v221, v187, v187
    v_fmac_f32 v220, v188, v188
    v_fmac_f32 v221, v189, v189
    v_fmac_f32 v220, v190, v190
    v_fmac_f32 v221, v191, v191
    v_mfma_f32_16x16x32_bf16 v[216:219], v[252:255], v[36:39], v[216:219]
    v_fmac_f32 v220, v192, v192
    v_fmac_f32 v221, v193, v193
    v_mfma_f32_32x32x16_bf16 v[120:135], v[16:19], v[48:51], 0
    v_fmac_f32 v220, v194, v194
    v_fmac_f32 v221, v195, v195
    v_fmac_f32 v220, v196, v196
    v_fmac_f32 v221, v197, v197
    v_fmac_f32 v220, v198, v198
    v_fmac_f32 v221, v199, v199
    v_mfma_f32_16x16x32_bf16 v[216:219], v[252:255], v[40:43], v[216:219]
    v_fmac_f32 v220, v200, v200
    v_fmac_f32 v221, v201, v201
    v_mfma_f32_32x32x16_bf16 v[120:135], v[20:23], v[52:55], v[120:135]
    v_fmac_f32 v220, v202, v202
    v_fmac_f32 v221, v203, v203
    v_fmac_f32 v220, v204, v204
    v_fmac_f32 v221, v205, v205
    v_fmac_f32 v220, v206, v206
    v_fmac_f32 v221, v207, v207
    v_mfma_f32_16x16x32_bf16 v[216:219], v[252:255], v[44:47], v[216:219]
    v_fmac_f32 v220, v208, v208
    v_fmac_f32 v221, v209, v209
    v_mfma_f32_32x32x16_bf16 v[136:151], v[16:19], v[56:59], 0
    v_fmac_f32 v220, v210, v210
    v_fmac_f32 v221, v211, v211
    v_fmac_f32 v220, v212, v212
    v_fmac_f32 v221, v213, v213
    v_fmac_f32 v220, v214, v214
    v_fmac_f32 v221, v215, v215
    v_mfma_f32_16x16x32_bf16 v[224:227], v[252:255], v[48:51], 0
    v_add_f32 v220, v220, v221
    v_mov_b32 v221, v220
    v_mfma_f32_32x32x16_bf16 v[136:151], v[20:23], v[60:63], v[136:151]
    s_nop 0
    v_permlane32_swap_b32 v220, v221
    v_add_f32 v220, v220, v221
    v_mul_f32 v216, s29, v216
    v_mul_f32 v220, s29, v220
    v_fma_f32 v220, -v216, v216, v220
    v_max_f32 v220, 0, v220
    v_mfma_f32_16x16x32_bf16 v[224:227], v[252:255], v[52:55], v[224:227]
    v_cvt_pk_bf16_f32 v220, v220, v220
    v_lshlrev_b32 v220, 16, v220
    v_mfma_f32_32x32x16_bf16 v[152:167], v[16:19], v[64:67], 0
    v_add_f32 v220, s30, v220
    v_cvt_pk_bf16_f32 v220, v220, v220
    v_lshlrev_b32 v220, 16, v220
    v_sqrt_f32 v220, v220
    v_cvt_pk_bf16_f32 v216, v216, v216
    v_mfma_f32_16x16x32_bf16 v[224:227], v[252:255], v[56:59], v[224:227]
    v_cvt_pk_bf16_f32 v220, v220, v220
    v_lshlrev_b32 v220, 16, v220
    v_mfma_f32_32x32x16_bf16 v[152:167], v[20:23], v[68:71], v[152:167]
    v_rcp_f32 v219, v220
    v_lshlrev_b32 v216, 16, v216
    v_mul_f32 v222, -v216, v219
    v_fma_f32 v168, v168, v219, v222
    v_fma_f32 v169, v169, v219, v222
    v_mfma_f32_16x16x32_bf16 v[224:227], v[252:255], v[60:63], v[224:227]
    v_fma_f32 v170, v170, v219, v222
    v_fma_f32 v171, v171, v219, v222
    v_fma_f32 v172, v172, v219, v222
    v_fma_f32 v173, v173, v219, v222
    v_fma_f32 v174, v174, v219, v222
    v_fma_f32 v175, v175, v219, v222
    v_mfma_f32_16x16x32_bf16 v[224:227], v[252:255], v[64:67], v[224:227]
    v_cvt_pk_bf16_f32 v72, v168, v169
    v_cvt_pk_bf16_f32 v73, v170, v171
    v_cvt_pk_bf16_f32 v74, v172, v173
    v_cvt_pk_bf16_f32 v75, v174, v175
    v_fma_f32 v184, v184, v219, v222
    v_fma_f32 v185, v185, v219, v222
    v_mfma_f32_16x16x32_bf16 v[224:227], v[252:255], v[68:71], v[224:227]
    v_fma_f32 v186, v186, v219, v222
    v_fma_f32 v187, v187, v219, v222
    v_fma_f32 v188, v188, v219, v222
    v_fma_f32 v189, v189, v219, v222
    v_fma_f32 v190, v190, v219, v222
    v_fma_f32 v191, v191, v219, v222
    v_fma_f32 v192, v192, v219, v222
    v_fma_f32 v193, v193, v219, v222
    v_fma_f32 v194, v194, v219, v222
    v_fma_f32 v195, v195, v219, v222
    v_fma_f32 v196, v196, v219, v222
    v_fma_f32 v197, v197, v219, v222
    v_fma_f32 v198, v198, v219, v222
    v_fma_f32 v199, v199, v219, v222
    v_mul_f32 v228, v120, v120
    v_mul_f32 v229, v121, v121
    v_cvt_pk_bf16_f32 v80, v184, v185
    v_cvt_pk_bf16_f32 v81, v186, v187
    v_cvt_pk_bf16_f32 v82, v188, v189
    v_cvt_pk_bf16_f32 v83, v190, v191
    v_cvt_pk_bf16_f32 v84, v192, v193
    v_cvt_pk_bf16_f32 v85, v194, v195
    v_cvt_pk_bf16_f32 v86, v196, v197
    v_cvt_pk_bf16_f32 v87, v198, v199
    s_waitcnt lgkmcnt(0)
    v_mfma_f32_32x32x16_bf16 v[184:199], v[248:251], v[72:75], 0
    v_fmac_f32 v228, v122, v122
    v_fmac_f32 v229, v123, v123
    v_fmac_f32 v228, v124, v124
    v_fmac_f32 v229, v125, v125
    v_fmac_f32 v228, v126, v126
    v_fmac_f32 v229, v127, v127
    v_fma_f32 v176, v176, v219, v222
    v_fma_f32 v177, v177, v219, v222
    v_fma_f32 v178, v178, v219, v222
    v_fma_f32 v179, v179, v219, v222
    v_fma_f32 v180, v180, v219, v222
    v_fma_f32 v181, v181, v219, v222
    v_fma_f32 v182, v182, v219, v222
    v_fma_f32 v183, v183, v219, v222
    v_fmac_f32 v228, v128, v128
    v_fmac_f32 v229, v129, v129
    v_cvt_pk_bf16_f32 v76, v176, v177
    v_cvt_pk_bf16_f32 v77, v178, v179
    v_cvt_pk_bf16_f32 v78, v180, v181
    v_cvt_pk_bf16_f32 v79, v182, v183
    v_fmac_f32 v228, v130, v130
    v_fmac_f32 v229, v131, v131
    v_mfma_f32_32x32x16_bf16 v[184:199], v[232:235], v[76:79], v[184:199]
    v_fmac_f32 v228, v132, v132
    v_fmac_f32 v229, v133, v133
    v_fmac_f32 v228, v134, v134
    v_fmac_f32 v229, v135, v135
    v_fmac_f32 v228, v136, v136
    v_fmac_f32 v229, v137, v137
    v_mfma_f32_32x32x16_bf16 v[184:199], v[236:239], v[80:83], v[184:199]
    ds_read_b128 v[232:235], v0 offset:6144
    v_fmac_f32 v228, v138, v138
    v_fmac_f32 v229, v139, v139
    v_fmac_f32 v228, v140, v140
    v_fmac_f32 v229, v141, v141
    v_fmac_f32 v228, v142, v142
    v_mfma_f32_32x32x16_bf16 v[184:199], v[240:243], v[84:87], v[184:199]
    v_fmac_f32 v229, v143, v143
    ds_read_b128 v[248:251], v0 offset:5120
    v_fmac_f32 v228, v144, v144
    v_fmac_f32 v229, v145, v145
    v_fmac_f32 v228, v146, v146
    v_fmac_f32 v229, v147, v147
    ds_read_b128 v[236:239], v0 offset:7168
    v_fmac_f32 v228, v148, v148
    v_fmac_f32 v229, v149, v149
    v_fmac_f32 v228, v150, v150
    v_fmac_f32 v229, v151, v151
    v_fmac_f32 v228, v152, v152
    v_fmac_f32 v229, v153, v153
    v_fmac_f32 v228, v154, v154
    v_fmac_f32 v229, v155, v155
    v_fmac_f32 v228, v156, v156
    v_fmac_f32 v229, v157, v157
    ds_read_b128 v[240:243], v0 offset:8192
    v_fma_f32 v200, v200, v219, v222
    v_fma_f32 v201, v201, v219, v222
    v_fma_f32 v202, v202, v219, v222
    v_fma_f32 v203, v203, v219, v222
    v_fma_f32 v204, v204, v219, v222
    v_fma_f32 v205, v205, v219, v222
    v_fma_f32 v206, v206, v219, v222
    v_fma_f32 v207, v207, v219, v222
    v_fmac_f32 v228, v158, v158
    v_fmac_f32 v229, v159, v159
    v_cvt_pk_bf16_f32 v88, v200, v201
    v_cvt_pk_bf16_f32 v89, v202, v203
    v_cvt_pk_bf16_f32 v90, v204, v205
    v_cvt_pk_bf16_f32 v91, v206, v207
    v_fmac_f32 v228, v160, v160
    v_fmac_f32 v229, v161, v161
    v_mfma_f32_32x32x16_bf16 v[184:199], v[244:247], v[88:91], v[184:199]
    v_fmac_f32 v228, v162, v162
    v_fmac_f32 v229, v163, v163
    v_fma_f32 v208, v208, v219, v222
    v_fma_f32 v209, v209, v219, v222
    v_fma_f32 v210, v210, v219, v222
    v_fma_f32 v211, v211, v219, v222
    v_fma_f32 v212, v212, v219, v222
    v_fma_f32 v213, v213, v219, v222
    v_fma_f32 v214, v214, v219, v222
    v_fma_f32 v215, v215, v219, v222
    v_fmac_f32 v228, v164, v164
    v_fmac_f32 v229, v165, v165
    v_cvt_pk_bf16_f32 v92, v208, v209
    v_cvt_pk_bf16_f32 v93, v210, v211
    v_cvt_pk_bf16_f32 v94, v212, v213
    v_cvt_pk_bf16_f32 v95, v214, v215
    s_waitcnt lgkmcnt(0)
    v_mfma_f32_32x32x16_bf16 v[200:215], v[232:235], v[72:75], 0
    v_fmac_f32 v228, v166, v166
    v_fmac_f32 v229, v167, v167
    ds_read_b128 v[244:247], v0 offset:9216
    v_add_f32 v228, v228, v229
    v_mov_b32 v229, v228
    v_mul_f32 v224, s29, v224
    v_mfma_f32_32x32x16_bf16 v[184:199], v[248:251], v[92:95], v[184:199]
    v_permlane32_swap_b32 v228, v229
    v_add_f32 v228, v228, v229
    ds_read_b128 v[248:251], v0 offset:10240
    v_mul_f32 v228, s29, v228
    v_fma_f32 v228, -v224, v224, v228
    v_max_f32 v228, 0, v228
    v_mfma_f32_32x32x16_bf16 v[200:215], v[236:239], v[76:79], v[200:215]
    ds_read_b128 v[236:239], v0 offset:12288
    v_cvt_pk_bf16_f32 v228, v228, v228
    v_lshlrev_b32 v228, 16, v228
    ds_read_b128 v[232:235], v0 offset:11264
    v_add_f32 v228, s30, v228
    v_cvt_pk_bf16_f32 v228, v228, v228
    v_mfma_f32_32x32x16_bf16 v[200:215], v[240:243], v[80:83], v[200:215]
    ds_read_b128 v[240:243], v0 offset:13312
    v_lshlrev_b32 v228, 16, v228
    v_sqrt_f32 v228, v228
    v_cvt_pk_bf16_f32 v224, v224, v224
    v_cvt_pk_bf16_f32 v228, v228, v228
    v_lshlrev_b32 v228, 16, v228
    v_rcp_f32 v227, v228
    s_waitcnt lgkmcnt(1)
    v_mfma_f32_32x32x16_bf16 v[200:215], v[244:247], v[84:87], v[200:215]
    ds_read_b128 v[244:247], v0 offset:14336
    v_lshlrev_b32 v224, 16, v224
    v_mul_f32 v230, -v224, v227
    v_fma_f32 v120, v120, v227, v230
    v_fma_f32 v121, v121, v227, v230
    v_fma_f32 v122, v122, v227, v230
    v_mfma_f32_32x32x16_bf16 v[200:215], v[248:251], v[88:91], v[200:215]
    v_fma_f32 v123, v123, v227, v230
    v_fma_f32 v124, v124, v227, v230
    v_fma_f32 v125, v125, v227, v230
    v_fma_f32 v126, v126, v227, v230
    v_fma_f32 v127, v127, v227, v230
    v_fma_f32 v128, v128, v227, v230
    v_mfma_f32_32x32x16_bf16 v[200:215], v[232:235], v[92:95], v[200:215]
    v_fma_f32 v129, v129, v227, v230
    v_fma_f32 v130, v130, v227, v230
    v_fma_f32 v131, v131, v227, v230
    v_fma_f32 v132, v132, v227, v230
    v_fma_f32 v133, v133, v227, v230
    v_fma_f32 v134, v134, v227, v230
    v_fma_f32 v135, v135, v227, v230
    v_fma_f32 v136, v136, v227, v230
    v_fma_f32 v137, v137, v227, v230
    v_fma_f32 v138, v138, v227, v230
    v_fma_f32 v139, v139, v227, v230
    v_fma_f32 v140, v140, v227, v230
    v_fma_f32 v141, v141, v227, v230
    v_fma_f32 v142, v142, v227, v230
    v_fma_f32 v143, v143, v227, v230
    v_fma_f32 v144, v144, v227, v230
    v_fma_f32 v145, v145, v227, v230
    v_fma_f32 v146, v146, v227, v230
    v_fma_f32 v147, v147, v227, v230
    v_fma_f32 v148, v148, v227, v230
    v_fma_f32 v149, v149, v227, v230
    v_fma_f32 v150, v150, v227, v230
    v_fma_f32 v151, v151, v227, v230
    v_fma_f32 v152, v152, v227, v230
    v_fma_f32 v153, v153, v227, v230
    v_fma_f32 v154, v154, v227, v230
    v_fma_f32 v155, v155, v227, v230
    v_fma_f32 v156, v156, v227, v230
    v_fma_f32 v157, v157, v227, v230
    v_fma_f32 v158, v158, v227, v230
    v_fma_f32 v159, v159, v227, v230
    v_fma_f32 v160, v160, v227, v230
    v_fma_f32 v161, v161, v227, v230
    v_fma_f32 v162, v162, v227, v230
    v_fma_f32 v163, v163, v227, v230
    v_fma_f32 v164, v164, v227, v230
    v_fma_f32 v165, v165, v227, v230
    v_fma_f32 v166, v166, v227, v230
    v_fma_f32 v167, v167, v227, v230
    v_mfma_f32_32x32x16_bf16 v[216:231], v[236:239], v[72:75], 0
    ds_read_b128 v[248:251], v0 offset:15360
    ds_read_b128 v[232:235], v0 offset:16384
    ds_read_b128 v[236:239], v0 offset:17408
    v_cvt_pk_bf16_f32 v96, v120, v121
    v_cvt_pk_bf16_f32 v97, v122, v123
    v_cvt_pk_bf16_f32 v98, v124, v125
    s_waitcnt lgkmcnt(3)
    v_mfma_f32_32x32x16_bf16 v[216:231], v[240:243], v[76:79], v[216:231]
    ds_read_b128 v[240:243], v0 offset:0
    v_cvt_pk_bf16_f32 v99, v126, v127
    v_cvt_pk_bf16_f32 v120, v184, v185
    v_cvt_pk_bf16_f32 v121, v186, v187
    v_cvt_pk_bf16_f32 v122, v188, v189
    v_cvt_pk_bf16_f32 v123, v190, v191
    v_mfma_f32_32x32x16_bf16 v[216:231], v[244:247], v[80:83], v[216:231]
    ds_read_b128 v[244:247], v0 offset:1024
    v_cvt_pk_bf16_f32 v124, v192, v193
    v_cvt_pk_bf16_f32 v125, v194, v195
    v_cvt_pk_bf16_f32 v126, v196, v197
    v_cvt_pk_bf16_f32 v127, v198, v199
    v_cvt_pk_bf16_f32 v100, v128, v129
    v_mfma_f32_32x32x16_bf16 v[168:183], v[72:75], v[120:123], 0
    v_cvt_pk_bf16_f32 v101, v130, v131
    v_cvt_pk_bf16_f32 v102, v132, v133
    v_cvt_pk_bf16_f32 v103, v134, v135
    v_cvt_pk_bf16_f32 v104, v136, v137
    v_cvt_pk_bf16_f32 v105, v138, v139
    v_cvt_pk_bf16_f32 v106, v140, v141
    s_waitcnt lgkmcnt(0)
    v_mfma_f32_32x32x16_bf16 v[216:231], v[248:251], v[84:87], v[216:231]
    ds_read_b128 v[248:251], v0 offset:2048
    v_cvt_pk_bf16_f32 v107, v142, v143
    v_cvt_pk_bf16_f32 v108, v144, v145
    v_cvt_pk_bf16_f32 v109, v146, v147
    v_cvt_pk_bf16_f32 v110, v148, v149
    v_cvt_pk_bf16_f32 v111, v150, v151
    v_mfma_f32_32x32x16_bf16 v[216:231], v[232:235], v[88:91], v[216:231]
    ds_read_b128 v[232:235], v0 offset:3072
    v_cvt_pk_bf16_f32 v112, v152, v153
    v_cvt_pk_bf16_f32 v113, v154, v155
    v_cvt_pk_bf16_f32 v114, v156, v157
    v_cvt_pk_bf16_f32 v115, v158, v159
    v_cvt_pk_bf16_f32 v116, v160, v161
    v_mfma_f32_32x32x16_bf16 v[184:199], v[240:243], v[96:99], 0
    ds_read_b128 v[240:243], v0 offset:5120
    v_cvt_pk_bf16_f32 v117, v162, v163
    v_cvt_pk_bf16_f32 v118, v164, v165
    v_cvt_pk_bf16_f32 v119, v166, v167
    v_cvt_pk_bf16_f32 v128, v200, v201
    v_cvt_pk_bf16_f32 v129, v202, v203
    v_mfma_f32_32x32x16_bf16 v[216:231], v[236:239], v[92:95], v[216:231]
    ds_read_b128 v[236:239], v0 offset:4096
    v_cvt_pk_bf16_f32 v130, v204, v205
    v_cvt_pk_bf16_f32 v131, v206, v207
    v_cvt_pk_bf16_f32 v132, v208, v209
    v_cvt_pk_bf16_f32 v133, v210, v211
    v_cvt_pk_bf16_f32 v134, v212, v213
    v_mfma_f32_32x32x16_bf16 v[184:199], v[244:247], v[100:103], v[184:199]
    ds_read_b128 v[244:247], v0 offset:6144
    v_cvt_pk_bf16_f32 v135, v214, v215
    s_waitcnt lgkmcnt(2)
    v_mfma_f32_32x32x16_bf16 v[184:199], v[248:251], v[104:107], v[184:199]
    ds_read_b128 v[248:251], v0 offset:7168
    v_cvt_pk_bf16_f32 v136, v216, v217
    v_cvt_pk_bf16_f32 v137, v218, v219
    v_cvt_pk_bf16_f32 v138, v220, v221
    v_cvt_pk_bf16_f32 v139, v222, v223
    v_cvt_pk_bf16_f32 v140, v224, v225
    v_mfma_f32_32x32x16_bf16 v[184:199], v[232:235], v[108:111], v[184:199]
    ds_read_b128 v[232:235], v0 offset:8192
    v_cvt_pk_bf16_f32 v141, v226, v227
    v_cvt_pk_bf16_f32 v142, v228, v229
    v_cvt_pk_bf16_f32 v143, v230, v231
    s_waitcnt lgkmcnt(1)
    v_mfma_f32_32x32x16_bf16 v[184:199], v[236:239], v[112:115], v[184:199]
    ds_read_b128 v[236:239], v0 offset:9216
    v_mfma_f32_32x32x16_bf16 v[184:199], v[240:243], v[116:119], v[184:199]
    ds_read_b128 v[240:243], v0 offset:10240
    v_mfma_f32_32x32x16_bf16 v[200:215], v[244:247], v[96:99], 0
    ds_read_b128 v[244:247], v0 offset:11264
    v_mfma_f32_32x32x16_bf16 v[200:215], v[248:251], v[100:103], v[200:215]
    s_nop 7
    v_cvt_pk_bf16_f32 v144, v184, v185
    v_cvt_pk_bf16_f32 v145, v186, v187
    v_cvt_pk_bf16_f32 v146, v188, v189
    v_cvt_pk_bf16_f32 v147, v190, v191
    v_cvt_pk_bf16_f32 v148, v192, v193
    v_cvt_pk_bf16_f32 v149, v194, v195
    v_mfma_f32_32x32x16_bf16 v[168:183], v[76:79], v[124:127], v[168:183]
    v_cvt_pk_bf16_f32 v150, v196, v197
    v_cvt_pk_bf16_f32 v151, v198, v199
    ds_read_b128 v[248:251], v0 offset:12288
    v_mfma_f32_32x32x16_bf16 v[184:199], v[96:99], v[120:123], 0
    v_mfma_f32_32x32x16_bf16 v[184:199], v[100:103], v[124:127], v[184:199]
    s_waitcnt lgkmcnt(1)
    v_mfma_f32_32x32x16_bf16 v[200:215], v[232:235], v[104:107], v[200:215]
    ds_read_b128 v[232:235], v0 offset:13312
    v_mfma_f32_32x32x16_bf16 v[168:183], v[80:83], v[128:131], v[168:183]
    v_mfma_f32_32x32x16_bf16 v[184:199], v[104:107], v[128:131], v[184:199]
    v_mfma_f32_32x32x16_bf16 v[200:215], v[236:239], v[108:111], v[200:215]
    ds_read_b128 v[236:239], v0 offset:14336
    v_mfma_f32_32x32x16_bf16 v[168:183], v[84:87], v[132:135], v[168:183]
    v_mfma_f32_32x32x16_bf16 v[184:199], v[108:111], v[132:135], v[184:199]
    v_mfma_f32_32x32x16_bf16 v[200:215], v[240:243], v[112:115], v[200:215]
    ds_read_b128 v[240:243], v0 offset:15360
    v_mfma_f32_32x32x16_bf16 v[168:183], v[88:91], v[136:139], v[168:183]
    s_waitcnt lgkmcnt(3)
    v_mfma_f32_32x32x16_bf16 v[216:231], v[248:251], v[96:99], 0
    ds_read_b128 v[248:251], v0 offset:17408
    v_mfma_f32_32x32x16_bf16 v[184:199], v[112:115], v[136:139], v[184:199]
    v_mfma_f32_32x32x16_bf16 v[200:215], v[244:247], v[116:119], v[200:215]
    ds_read_b128 v[244:247], v0 offset:16384
    v_mfma_f32_32x32x16_bf16 v[168:183], v[92:95], v[140:143], v[168:183]
    s_waitcnt lgkmcnt(3)
    v_mfma_f32_32x32x16_bf16 v[216:231], v[232:235], v[100:103], v[216:231]
    s_nop 7
    v_cvt_pk_bf16_f32 v152, v200, v201
    v_cvt_pk_bf16_f32 v153, v202, v203
    v_cvt_pk_bf16_f32 v154, v204, v205
    v_cvt_pk_bf16_f32 v155, v206, v207
    v_cvt_pk_bf16_f32 v156, v208, v209
    v_cvt_pk_bf16_f32 v157, v210, v211
    v_mfma_f32_32x32x16_bf16 v[184:199], v[116:119], v[140:143], v[184:199]
    v_max3_f32 v120, v168, v169, v170
    v_max3_f32 v120, v120, v171, v172
    v_max3_f32 v121, v176, v177, v178
    v_max3_f32 v120, v120, v173, v174
    v_max3_f32 v121, v121, v179, v180
    v_max3_f32 v121, v121, v181, v182
    v_mfma_f32_32x32x16_bf16 v[216:231], v[236:239], v[104:107], v[216:231]
    v_max3_f32 v120, v120, v175, v183
    v_cvt_pk_bf16_f32 v158, v212, v213
    v_cvt_pk_bf16_f32 v159, v214, v215
    ds_read_b128 v[232:235], v0 offset:18432
    ds_read_b128 v[236:239], v0 offset:19456
    s_waitcnt lgkmcnt(2)
    v_mfma_f32_32x32x16_bf16 v[216:231], v[240:243], v[108:111], v[216:231]
    v_max3_f32 v122, v184, v185, v186
    v_max3_f32 v123, v192, v193, v194
    v_max3_f32 v122, v122, v187, v188
    v_max3_f32 v123, v123, v195, v196
    v_max3_f32 v122, v122, v189, v190
    v_max3_f32 v123, v123, v197, v198
    v_mfma_f32_32x32x16_bf16 v[216:231], v[244:247], v[112:115], v[216:231]
    v_max3_f32 v121, v121, v191, v199
    v_max3_f32 v120, v120, v122, v123
    v_max_f32 v120, v120, v121
    v_mov_b32 v124, v120
    ds_read_b128 v[240:243], v0 offset:20480
    ds_read_b128 v[244:247], v0 offset:21504
    v_mfma_f32_32x32x16_bf16 v[216:231], v[248:251], v[116:119], v[216:231]
    v_permlane32_swap_b32 v120, v124
    v_max_f32 v120, v120, v124
    v_mul_f32 v120, s28, v120
    v_fma_f32 v168, v168, s28, -v120
    v_fma_f32 v169, v169, s28, -v120
    v_fma_f32 v170, v170, s28, -v120
    v_mfma_f32_32x32x16_bf16 v[200:215], v[72:75], v[144:147], 0
    v_fma_f32 v171, v171, s28, -v120
    v_fma_f32 v172, v172, s28, -v120
    v_fma_f32 v173, v173, s28, -v120
    v_fma_f32 v174, v174, s28, -v120
    v_fma_f32 v175, v175, s28, -v120
    v_exp_f32 v168, v168
    v_mfma_f32_32x32x16_bf16 v[200:215], v[76:79], v[148:151], v[200:215]
    v_exp_f32 v169, v169
    v_exp_f32 v170, v170
    v_exp_f32 v171, v171
    v_mfma_f32_32x32x16_bf16 v[200:215], v[80:83], v[152:155], v[200:215]
    v_exp_f32 v172, v172
    v_exp_f32 v173, v173
    v_exp_f32 v174, v174
    v_mfma_f32_32x32x16_bf16 v[200:215], v[84:87], v[156:159], v[200:215]
    v_exp_f32 v175, v175
    v_fma_f32 v176, v176, s28, -v120
    v_fma_f32 v177, v177, s28, -v120
    v_fma_f32 v178, v178, s28, -v120
    v_fma_f32 v179, v179, s28, -v120
    v_exp_f32 v176, v176
    v_exp_f32 v177, v177
    v_exp_f32 v178, v178
    v_exp_f32 v179, v179
    v_fma_f32 v180, v180, s28, -v120
    v_fma_f32 v181, v181, s28, -v120
    v_fma_f32 v182, v182, s28, -v120
    v_fma_f32 v183, v183, s28, -v120
    v_exp_f32 v180, v180
    v_exp_f32 v181, v181
    v_exp_f32 v182, v182
    v_exp_f32 v183, v183
    v_fma_f32 v184, v184, s28, -v120
    v_fma_f32 v185, v185, s28, -v120
    v_fma_f32 v186, v186, s28, -v120
    v_fma_f32 v187, v187, s28, -v120
    v_add_f32 v125, v168, v172
    v_add_f32 v126, v169, v173
    v_add_f32 v127, v170, v174
    v_add_f32 v121, v171, v175
    v_exp_f32 v184, v184
    v_exp_f32 v185, v185
    v_exp_f32 v186, v186
    v_exp_f32 v187, v187
    v_fma_f32 v188, v188, s28, -v120
    v_fma_f32 v189, v189, s28, -v120
    v_fma_f32 v190, v190, s28, -v120
    v_fma_f32 v191, v191, s28, -v120
    v_add_f32 v125, v125, v176
    v_add_f32 v126, v126, v177
    v_add_f32 v127, v127, v178
    v_add_f32 v121, v121, v179
    v_exp_f32 v188, v188
    v_exp_f32 v189, v189
    v_exp_f32 v190, v190
    v_exp_f32 v191, v191
    v_fma_f32 v192, v192, s28, -v120
    v_fma_f32 v193, v193, s28, -v120
    v_fma_f32 v194, v194, s28, -v120
    v_fma_f32 v195, v195, s28, -v120
    v_add_f32 v125, v125, v180
    v_add_f32 v126, v126, v181
    v_add_f32 v127, v127, v182
    v_add_f32 v121, v121, v183
    v_exp_f32 v192, v192
    v_exp_f32 v193, v193
    v_exp_f32 v194, v194
    v_exp_f32 v195, v195
    v_fma_f32 v196, v196, s28, -v120
    v_fma_f32 v197, v197, s28, -v120
    v_fma_f32 v198, v198, s28, -v120
    v_fma_f32 v199, v199, s28, -v120
    v_add_f32 v125, v125, v184
    v_add_f32 v126, v126, v185
    v_add_f32 v127, v127, v186
    v_add_f32 v121, v121, v187
    v_exp_f32 v196, v196
    v_exp_f32 v197, v197
    v_exp_f32 v198, v198
    v_exp_f32 v199, v199
    v_add_f32 v125, v125, v188
    v_add_f32 v126, v126, v189
    v_add_f32 v127, v127, v190
    v_add_f32 v121, v121, v191
    v_add_f32 v125, v125, v192
    v_add_f32 v126, v126, v193
    v_add_f32 v127, v127, v194
    v_add_f32 v121, v121, v195
    v_add_f32 v125, v125, v196
    v_add_f32 v126, v126, v197
    v_add_f32 v127, v127, v198
    v_add_f32 v121, v121, v199
    v_cvt_pk_bf16_f32 v160, v216, v217
    v_cvt_pk_bf16_f32 v161, v218, v219
    v_cvt_pk_bf16_f32 v162, v220, v221
    v_cvt_pk_bf16_f32 v163, v222, v223
    v_cvt_pk_bf16_f32 v164, v224, v225
    v_cvt_pk_bf16_f32 v165, v226, v227
    v_mfma_f32_32x32x16_bf16 v[200:215], v[88:91], v[160:163], v[200:215]
    v_cvt_pk_bf16_f32 v166, v228, v229
    v_cvt_pk_bf16_f32 v167, v230, v231
    v_add_f32 v125, v125, v126
    v_add_f32 v127, v127, v121
    v_add_f32 v125, v125, v127
    v_mov_b32 v124, v125
    v_mfma_f32_32x32x16_bf16 v[216:231], v[96:99], v[144:147], 0
    s_nop 0
    v_permlane32_swap_b32 v125, v124
    v_add_f32 v125, v125, v124
    v_rcp_f32 v125, v125
    ds_read_b128 v[248:251], v0 offset:22528
    v_mul_f32 v168, v168, v125
    v_mfma_f32_32x32x16_bf16 v[216:231], v[100:103], v[148:151], v[216:231]
    v_mul_f32 v169, v169, v125
    v_cvt_pk_bf16_f32 v168, v168, v169
    v_mul_f32 v170, v170, v125
    v_mul_f32 v171, v171, v125
    v_cvt_pk_bf16_f32 v169, v170, v171
    v_mul_f32 v172, v172, v125
    v_mfma_f32_32x32x16_bf16 v[216:231], v[104:107], v[152:155], v[216:231]
    v_mul_f32 v173, v173, v125
    v_mul_f32 v174, v174, v125
    v_mul_f32 v175, v175, v125
    v_cvt_pk_bf16_f32 v170, v172, v173
    v_cvt_pk_bf16_f32 v171, v174, v175
    v_mul_f32 v176, v176, v125
    v_mfma_f32_32x32x16_bf16 v[216:231], v[108:111], v[156:159], v[216:231]
    v_mul_f32 v177, v177, v125
    v_mul_f32 v178, v178, v125
    v_mul_f32 v179, v179, v125
    v_mul_f32 v180, v180, v125
    v_mul_f32 v181, v181, v125
    v_mul_f32 v182, v182, v125
    v_mfma_f32_32x32x16_bf16 v[216:231], v[112:115], v[160:163], v[216:231]
    v_mul_f32 v183, v183, v125
    v_cvt_pk_bf16_f32 v172, v176, v177
    v_cvt_pk_bf16_f32 v173, v178, v179
    v_cvt_pk_bf16_f32 v174, v180, v181
    v_cvt_pk_bf16_f32 v175, v182, v183
    v_mul_f32 v184, v184, v125
    s_waitcnt lgkmcnt(0)
    v_mfma_f32_32x32x16_bf16 v[136:151], v[96:99], v[232:235], 0
    v_mul_f32 v185, v185, v125
    v_mul_f32 v186, v186, v125
    v_mul_f32 v187, v187, v125
    v_mul_f32 v188, v188, v125
    v_mul_f32 v189, v189, v125
    v_mul_f32 v190, v190, v125
    v_mfma_f32_32x32x16_bf16 v[200:215], v[92:95], v[164:167], v[200:215]
    v_mul_f32 v191, v191, v125
    v_mul_f32 v192, v192, v125
    v_mul_f32 v193, v193, v125
    v_mul_f32 v194, v194, v125
    v_mul_f32 v195, v195, v125
    v_mul_f32 v196, v196, v125
    v_mfma_f32_32x32x16_bf16 v[216:231], v[116:119], v[164:167], v[216:231]
    v_mul_f32 v197, v197, v125
    v_mul_f32 v198, v198, v125
    v_mul_f32 v199, v199, v125
    v_cvt_pk_bf16_f32 v176, v184, v185
    v_cvt_pk_bf16_f32 v177, v186, v187
    v_cvt_pk_bf16_f32 v178, v188, v189
    v_mfma_f32_32x32x16_bf16 v[136:151], v[100:103], v[236:239], v[136:151]
    v_cvt_pk_bf16_f32 v179, v190, v191
    v_cvt_pk_bf16_f32 v180, v192, v193
    v_cvt_pk_bf16_f32 v181, v194, v195
    v_cvt_pk_bf16_f32 v182, v196, v197
    v_cvt_pk_bf16_f32 v183, v198, v199
    v_max3_f32 v128, v200, v201, v202
    v_mfma_f32_32x32x16_bf16 v[184:199], v[72:75], v[232:235], 0
    ds_read_b128 v[232:235], v0 offset:23552
    v_max3_f32 v128, v128, v203, v204
    v_max3_f32 v129, v208, v209, v210
    v_max3_f32 v130, v216, v217, v218
    v_max3_f32 v131, v224, v225, v226
    v_max3_f32 v128, v128, v205, v206
    v_mfma_f32_32x32x16_bf16 v[184:199], v[76:79], v[236:239], v[184:199]
    ds_read_b128 v[236:239], v0 offset:24576
    v_max3_f32 v129, v129, v211, v212
    v_max3_f32 v130, v130, v219, v220
    v_max3_f32 v131, v131, v227, v228
    v_max3_f32 v129, v129, v213, v214
    v_max3_f32 v130, v130, v221, v222
    v_mfma_f32_32x32x16_bf16 v[184:199], v[80:83], v[240:243], v[184:199]
    v_max3_f32 v131, v131, v229, v230
    v_max3_f32 v128, v128, v207, v215
    v_max3_f32 v129, v129, v223, v231
    v_max3_f32 v128, v128, v130, v131
    v_max_f32 v128, v128, v129
    v_mov_b32 v132, v128
    v_mfma_f32_32x32x16_bf16 v[184:199], v[84:87], v[244:247], v[184:199]
    s_nop 0
    v_permlane32_swap_b32 v128, v132
    v_max_f32 v128, v128, v132
    v_mul_f32 v128, s28, v128
    v_fma_f32 v200, v200, s28, -v128
    v_fma_f32 v201, v201, s28, -v128
    v_fma_f32 v202, v202, s28, -v128
    v_mfma_f32_32x32x16_bf16 v[136:151], v[104:107], v[240:243], v[136:151]
    ds_read_b128 v[240:243], v0 offset:25600
    v_fma_f32 v203, v203, s28, -v128
    v_fma_f32 v204, v204, s28, -v128
    v_fma_f32 v205, v205, s28, -v128
    v_fma_f32 v206, v206, s28, -v128
    v_fma_f32 v207, v207, s28, -v128
    v_mfma_f32_32x32x16_bf16 v[184:199], v[88:91], v[248:251], v[184:199]
    v_exp_f32 v200, v200
    v_exp_f32 v201, v201
    v_exp_f32 v202, v202
    v_mfma_f32_32x32x16_bf16 v[136:151], v[108:111], v[244:247], v[136:151]
    ds_read_b128 v[244:247], v0 offset:26624
    v_exp_f32 v203, v203
    v_exp_f32 v204, v204
    v_exp_f32 v205, v205
    s_waitcnt lgkmcnt(1)
    v_mfma_f32_32x32x16_bf16 v[184:199], v[92:95], v[232:235], v[184:199]
    v_exp_f32 v206, v206
    v_exp_f32 v207, v207
    v_fma_f32 v208, v208, s28, -v128
    v_fma_f32 v209, v209, s28, -v128
    v_mfma_f32_32x32x16_bf16 v[136:151], v[112:115], v[248:251], v[136:151]
    v_fma_f32 v210, v210, s28, -v128
    v_fma_f32 v211, v211, s28, -v128
    v_exp_f32 v208, v208
    v_exp_f32 v209, v209
    v_mfma_f32_32x32x16_bf16 v[136:151], v[116:119], v[232:235], v[136:151]
    v_exp_f32 v210, v210
    v_exp_f32 v211, v211
    v_fma_f32 v212, v212, s28, -v128
    v_fma_f32 v213, v213, s28, -v128
    v_fma_f32 v214, v214, s28, -v128
    v_fma_f32 v215, v215, s28, -v128
    v_exp_f32 v212, v212
    v_exp_f32 v213, v213
    v_exp_f32 v214, v214
    v_exp_f32 v215, v215
    v_fma_f32 v216, v216, s28, -v128
    v_fma_f32 v217, v217, s28, -v128
    v_fma_f32 v218, v218, s28, -v128
    v_fma_f32 v219, v219, s28, -v128
    v_add_f32 v133, v200, v204
    v_add_f32 v134, v201, v205
    v_add_f32 v135, v202, v206
    v_add_f32 v129, v203, v207
    v_exp_f32 v216, v216
    v_exp_f32 v217, v217
    v_exp_f32 v218, v218
    v_exp_f32 v219, v219
    v_fma_f32 v220, v220, s28, -v128
    v_fma_f32 v221, v221, s28, -v128
    v_fma_f32 v222, v222, s28, -v128
    v_fma_f32 v223, v223, s28, -v128
    v_cvt_pk_bf16_f32 v152, v184, v185
    v_cvt_pk_bf16_f32 v153, v186, v187
    v_cvt_pk_bf16_f32 v154, v188, v189
    v_cvt_pk_bf16_f32 v155, v190, v191
    v_cvt_pk_bf16_f32 v156, v192, v193
    v_cvt_pk_bf16_f32 v157, v194, v195
    v_cvt_pk_bf16_f32 v158, v196, v197
    v_cvt_pk_bf16_f32 v159, v198, v199
    v_mfma_f32_32x32x16_bf16 v[184:199], v[72:75], v[236:239], 0
    v_add_f32 v133, v133, v208
    v_add_f32 v134, v134, v209
    v_add_f32 v135, v135, v210
    v_add_f32 v129, v129, v211
    ds_read_b128 v[248:251], v0 offset:27648
    v_exp_f32 v220, v220
    v_mfma_f32_32x32x16_bf16 v[184:199], v[76:79], v[240:243], v[184:199]
    v_exp_f32 v221, v221
    v_exp_f32 v222, v222
    v_exp_f32 v223, v223
    s_waitcnt lgkmcnt(1)
    v_mfma_f32_32x32x16_bf16 v[184:199], v[80:83], v[244:247], v[184:199]
    v_fma_f32 v224, v224, s28, -v128
    v_fma_f32 v225, v225, s28, -v128
    v_fma_f32 v226, v226, s28, -v128
    v_fma_f32 v227, v227, s28, -v128
    v_add_f32 v133, v133, v212
    v_add_f32 v134, v134, v213
    v_add_f32 v135, v135, v214
    v_add_f32 v129, v129, v215
    v_exp_f32 v224, v224
    v_exp_f32 v225, v225
    v_exp_f32 v226, v226
    v_exp_f32 v227, v227
    v_fma_f32 v228, v228, s28, -v128
    s_waitcnt lgkmcnt(0)
    v_mfma_f32_32x32x16_bf16 v[184:199], v[84:87], v[248:251], v[184:199]
    v_fma_f32 v229, v229, s28, -v128
    v_fma_f32 v230, v230, s28, -v128
    v_fma_f32 v231, v231, s28, -v128
    v_add_f32 v133, v133, v216
    v_add_f32 v134, v134, v217
    v_add_f32 v135, v135, v218
    v_add_f32 v129, v129, v219
    v_exp_f32 v228, v228
    v_exp_f32 v229, v229
    v_exp_f32 v230, v230
    v_exp_f32 v231, v231
    v_add_f32 v133, v133, v220
    v_add_f32 v134, v134, v221
    v_add_f32 v135, v135, v222
    v_add_f32 v129, v129, v223
    v_add_f32 v133, v133, v224
    v_add_f32 v134, v134, v225
    v_add_f32 v135, v135, v226
    v_add_f32 v129, v129, v227
    v_add_f32 v133, v133, v228
    v_add_f32 v134, v134, v229
    v_add_f32 v135, v135, v230
    v_add_f32 v129, v129, v231
    ds_read_b128 v[232:235], v0 offset:28672
    v_add_f32 v133, v133, v134
    v_add_f32 v135, v135, v129
    v_add_f32 v133, v133, v135
    v_cvt_pk_bf16_f32 v160, v136, v137
    v_cvt_pk_bf16_f32 v161, v138, v139
    v_cvt_pk_bf16_f32 v162, v140, v141
    v_cvt_pk_bf16_f32 v163, v142, v143
    v_cvt_pk_bf16_f32 v164, v144, v145
    v_cvt_pk_bf16_f32 v165, v146, v147
    v_cvt_pk_bf16_f32 v166, v148, v149
    v_cvt_pk_bf16_f32 v167, v150, v151
    v_mfma_f32_32x32x16_bf16 v[136:151], v[96:99], v[236:239], 0
    v_mov_b32 v132, v133
    ds_read_b128 v[236:239], v0 offset:29696
    v_lshlrev_b32 v120, 16, v24
    v_permlane32_swap_b32 v133, v132
    v_add_f32 v133, v133, v132
    v_rcp_f32 v133, v133
    v_mfma_f32_32x32x16_bf16 v[136:151], v[100:103], v[240:243], v[136:151]
    v_mul_f32 v200, v200, v133
    v_mul_f32 v201, v201, v133
    v_mul_f32 v202, v202, v133
    v_mul_f32 v203, v203, v133
    v_mul_f32 v204, v204, v133
    v_mul_f32 v205, v205, v133
    v_mfma_f32_32x32x16_bf16 v[136:151], v[104:107], v[244:247], v[136:151]
    v_mul_f32 v206, v206, v133
    v_mul_f32 v207, v207, v133
    v_mul_f32 v208, v208, v133
    v_mul_f32 v209, v209, v133
    v_mul_f32 v210, v210, v133
    v_mul_f32 v211, v211, v133
    s_waitcnt lgkmcnt(0)
    v_mfma_f32_32x32x16_bf16 v[184:199], v[88:91], v[232:235], v[184:199]
    v_mul_f32 v212, v212, v133
    v_mul_f32 v213, v213, v133
    v_mul_f32 v214, v214, v133
    v_mul_f32 v215, v215, v133
    v_mul_f32 v216, v216, v133
    v_mul_f32 v217, v217, v133
    v_mfma_f32_32x32x16_bf16 v[136:151], v[108:111], v[248:251], v[136:151]
    v_mul_f32 v218, v218, v133
    v_mul_f32 v219, v219, v133
    v_mul_f32 v220, v220, v133
    v_mul_f32 v221, v221, v133
    v_mul_f32 v222, v222, v133
    v_mul_f32 v223, v223, v133
    v_mfma_f32_32x32x16_bf16 v[184:199], v[92:95], v[236:239], v[184:199]
    v_mul_f32 v224, v224, v133
    v_mul_f32 v225, v225, v133
    v_mul_f32 v226, v226, v133
    v_mul_f32 v227, v227, v133
    v_mul_f32 v228, v228, v133
    v_mul_f32 v229, v229, v133
    v_mfma_f32_32x32x16_bf16 v[136:151], v[112:115], v[232:235], v[136:151]
    v_mul_f32 v230, v230, v133
    v_mul_f32 v231, v231, v133
    v_and_b32 v121, s31, v24
    v_lshlrev_b32 v122, 16, v25
    v_and_b32 v123, s31, v25
    v_lshlrev_b32 v124, 16, v26
    v_mfma_f32_32x32x16_bf16 v[136:151], v[116:119], v[236:239], v[136:151]
    v_and_b32 v125, s31, v26
    v_lshlrev_b32 v126, 16, v27
    v_and_b32 v127, s31, v27
    v_lshlrev_b32 v128, 16, v28
    v_and_b32 v129, s31, v28
    v_lshlrev_b32 v130, 16, v29
    v_and_b32 v131, s31, v29
    v_lshlrev_b32 v132, 16, v30
    v_and_b32 v133, s31, v30
    v_lshlrev_b32 v134, 16, v31
    v_and_b32 v135, s31, v31
    v_cvt_pk_bf16_f32 v200, v200, v201
    v_cvt_pk_bf16_f32 v201, v202, v203
    v_mfma_f32_32x32x16_bf16 v[120:135], v[152:155], v[168:171], v[120:135]
    ds_read_b128 v[240:243], v0 offset:30720
    v_cvt_pk_bf16_f32 v202, v204, v205
    v_cvt_pk_bf16_f32 v203, v206, v207
    v_cvt_pk_bf16_f32 v204, v208, v209
    v_cvt_pk_bf16_f32 v205, v210, v211
    v_cvt_pk_bf16_f32 v206, v212, v213
    v_mfma_f32_32x32x16_bf16 v[120:135], v[156:159], v[172:175], v[120:135]
    v_cvt_pk_bf16_f32 v207, v214, v215
    v_cvt_pk_bf16_f32 v208, v216, v217
    v_cvt_pk_bf16_f32 v209, v218, v219
    v_cvt_pk_bf16_f32 v210, v220, v221
    v_cvt_pk_bf16_f32 v211, v222, v223
    v_cvt_pk_bf16_f32 v212, v224, v225
    v_mfma_f32_32x32x16_bf16 v[120:135], v[160:163], v[176:179], v[120:135]
    v_cvt_pk_bf16_f32 v213, v226, v227
    v_cvt_pk_bf16_f32 v214, v228, v229
    v_cvt_pk_bf16_f32 v215, v230, v231
    v_lshlrev_b32 v216, 16, v48
    v_and_b32 v217, s31, v48
    v_lshlrev_b32 v218, 16, v49
    v_mfma_f32_32x32x16_bf16 v[120:135], v[164:167], v[180:183], v[120:135]
    v_and_b32 v219, s31, v49
    v_lshlrev_b32 v220, 16, v50
    v_and_b32 v221, s31, v50
    v_lshlrev_b32 v222, 16, v51
    v_and_b32 v223, s31, v51
    v_lshlrev_b32 v224, 16, v52
    v_and_b32 v225, s31, v52
    v_lshlrev_b32 v226, 16, v53
    v_and_b32 v227, s31, v53
    v_lshlrev_b32 v228, 16, v54
    v_and_b32 v229, s31, v54
    v_lshlrev_b32 v230, 16, v55
    v_and_b32 v231, s31, v55
    ds_read_b128 v[244:247], v0 offset:31744
    ds_read_b128 v[248:251], v0 offset:32768
    v_mfma_f32_32x32x16_bf16 v[216:231], v[152:155], v[200:203], v[216:231]
    v_cvt_pk_bf16_f32 v152, v184, v185
    v_cvt_pk_bf16_f32 v153, v186, v187
    v_cvt_pk_bf16_f32 v154, v188, v189
    v_cvt_pk_bf16_f32 v155, v190, v191
    ds_read_b128 v[232:235], v0 offset:33792
    ds_read_b128 v[236:239], v0 offset:34816
    v_mfma_f32_32x32x16_bf16 v[216:231], v[156:159], v[204:207], v[216:231]
    v_cvt_pk_bf16_f32 v156, v192, v193
    v_cvt_pk_bf16_f32 v157, v194, v195
    v_cvt_pk_bf16_f32 v158, v196, v197
    v_cvt_pk_bf16_f32 v159, v198, v199
    v_cvt_pk_bf16_f32 v24, v120, v121
    v_cvt_pk_bf16_f32 v25, v122, v123
    s_waitcnt lgkmcnt(2)
    v_mfma_f32_32x32x16_bf16 v[184:199], v[72:75], v[240:243], 0
    v_cvt_pk_bf16_f32 v26, v124, v125
    v_cvt_pk_bf16_f32 v27, v126, v127
    v_cvt_pk_bf16_f32 v28, v128, v129
    v_cvt_pk_bf16_f32 v29, v130, v131
    v_cvt_pk_bf16_f32 v30, v132, v133
    v_cvt_pk_bf16_f32 v31, v134, v135
    v_mfma_f32_32x32x16_bf16 v[216:231], v[160:163], v[208:211], v[216:231]
    v_cvt_pk_bf16_f32 v160, v136, v137
    v_cvt_pk_bf16_f32 v161, v138, v139
    v_cvt_pk_bf16_f32 v162, v140, v141
    v_cvt_pk_bf16_f32 v163, v142, v143
    v_lshlrev_b32 v120, 16, v32
    v_and_b32 v121, s31, v32
    v_mfma_f32_32x32x16_bf16 v[184:199], v[76:79], v[244:247], v[184:199]
    v_lshlrev_b32 v122, 16, v33
    v_and_b32 v123, s31, v33
    v_lshlrev_b32 v124, 16, v34
    v_and_b32 v125, s31, v34
    v_lshlrev_b32 v126, 16, v35
    v_and_b32 v127, s31, v35
    v_mfma_f32_32x32x16_bf16 v[216:231], v[164:167], v[212:215], v[216:231]
    v_cvt_pk_bf16_f32 v164, v144, v145
    v_cvt_pk_bf16_f32 v165, v146, v147
    v_cvt_pk_bf16_f32 v166, v148, v149
    v_cvt_pk_bf16_f32 v167, v150, v151
    v_lshlrev_b32 v128, 16, v36
    v_and_b32 v129, s31, v36
    v_mfma_f32_32x32x16_bf16 v[136:151], v[96:99], v[240:243], 0
    v_lshlrev_b32 v130, 16, v37
    v_and_b32 v131, s31, v37
    v_lshlrev_b32 v132, 16, v38
    v_and_b32 v133, s31, v38
    v_lshlrev_b32 v134, 16, v39
    v_and_b32 v135, s31, v39
    v_mfma_f32_32x32x16_bf16 v[184:199], v[80:83], v[248:251], v[184:199]
    ds_read_b128 v[240:243], v0 offset:35840
    v_cvt_pk_bf16_f32 v48, v216, v217
    v_cvt_pk_bf16_f32 v49, v218, v219
    v_cvt_pk_bf16_f32 v50, v220, v221
    v_cvt_pk_bf16_f32 v51, v222, v223
    v_cvt_pk_bf16_f32 v52, v224, v225
    v_mfma_f32_32x32x16_bf16 v[120:135], v[152:155], v[168:171], v[120:135]
    v_cvt_pk_bf16_f32 v53, v226, v227
    v_cvt_pk_bf16_f32 v54, v228, v229
    v_cvt_pk_bf16_f32 v55, v230, v231
    v_lshlrev_b32 v216, 16, v56
    v_and_b32 v217, s31, v56
    v_lshlrev_b32 v218, 16, v57
    v_mfma_f32_32x32x16_bf16 v[120:135], v[156:159], v[172:175], v[120:135]
    v_and_b32 v219, s31, v57
    v_lshlrev_b32 v220, 16, v58
    v_and_b32 v221, s31, v58
    v_lshlrev_b32 v222, 16, v59
    v_and_b32 v223, s31, v59
    v_lshlrev_b32 v224, 16, v60
    v_mfma_f32_32x32x16_bf16 v[136:151], v[100:103], v[244:247], v[136:151]
    v_and_b32 v225, s31, v60
    v_lshlrev_b32 v226, 16, v61
    v_and_b32 v227, s31, v61
    v_lshlrev_b32 v228, 16, v62
    v_and_b32 v229, s31, v62
    v_lshlrev_b32 v230, 16, v63
    s_waitcnt lgkmcnt(0)
    v_mfma_f32_32x32x16_bf16 v[184:199], v[84:87], v[232:235], v[184:199]
    v_and_b32 v231, s31, v63
    ds_write_b128 v2, v[24:27] offset:0
    ds_write_b128 v2, v[28:31] offset:16
    buffer_load_dwordx4 v[72:75], v6, s[76:79], s40 offen sc1 nt
    v_mfma_f32_32x32x16_bf16 v[120:135], v[160:163], v[176:179], v[120:135]
    buffer_load_dwordx4 v[76:79], v1, s[76:79], s41 offen sc1 nt
    buffer_load_dwordx4 v[80:83], v6, s[76:79], s42 offen sc1 nt
    buffer_load_dwordx4 v[84:87], v6, s[76:79], s43 offen sc1 nt
    v_mfma_f32_32x32x16_bf16 v[216:231], v[152:155], v[200:203], v[216:231]
    v_mfma_f32_32x32x16_bf16 v[136:151], v[104:107], v[248:251], v[136:151]
    v_mfma_f32_32x32x16_bf16 v[184:199], v[88:91], v[236:239], v[184:199]
    buffer_load_dwordx4 v[88:91], v1, s[76:79], s44 offen sc1 nt
    v_mfma_f32_32x32x16_bf16 v[120:135], v[164:167], v[180:183], v[120:135]
    v_mfma_f32_32x32x16_bf16 v[216:231], v[156:159], v[204:207], v[216:231]
    v_mfma_f32_32x32x16_bf16 v[136:151], v[108:111], v[232:235], v[136:151]
    s_nop 9
    v_cvt_pk_bf16_f32 v32, v120, v121
    v_cvt_pk_bf16_f32 v33, v122, v123
    v_cvt_pk_bf16_f32 v34, v124, v125
    v_cvt_pk_bf16_f32 v35, v126, v127
    v_cvt_pk_bf16_f32 v36, v128, v129
    v_cvt_pk_bf16_f32 v37, v130, v131
    v_mfma_f32_32x32x16_bf16 v[184:199], v[92:95], v[240:243], v[184:199]
    v_cvt_pk_bf16_f32 v38, v132, v133
    v_cvt_pk_bf16_f32 v39, v134, v135
    v_lshlrev_b32 v120, 16, v40
    v_and_b32 v121, s31, v40
    v_lshlrev_b32 v122, 16, v41
    v_and_b32 v123, s31, v41
    v_mfma_f32_32x32x16_bf16 v[216:231], v[160:163], v[208:211], v[216:231]
    v_lshlrev_b32 v124, 16, v42
    v_and_b32 v125, s31, v42
    v_lshlrev_b32 v126, 16, v43
    v_and_b32 v127, s31, v43
    v_lshlrev_b32 v128, 16, v44
    v_and_b32 v129, s31, v44
    v_mfma_f32_32x32x16_bf16 v[136:151], v[112:115], v[236:239], v[136:151]
    v_cvt_pk_bf16_f32 v152, v184, v185
    v_cvt_pk_bf16_f32 v153, v186, v187
    v_cvt_pk_bf16_f32 v154, v188, v189
    v_cvt_pk_bf16_f32 v155, v190, v191
    v_lshlrev_b32 v130, 16, v45
    v_and_b32 v131, s31, v45
    v_mfma_f32_32x32x16_bf16 v[216:231], v[164:167], v[212:215], v[216:231]
    v_lshlrev_b32 v132, 16, v46
    v_and_b32 v133, s31, v46
    v_lshlrev_b32 v134, 16, v47
    v_and_b32 v135, s31, v47
    v_cvt_pk_bf16_f32 v156, v192, v193
    v_cvt_pk_bf16_f32 v157, v194, v195
    v_mfma_f32_32x32x16_bf16 v[136:151], v[116:119], v[240:243], v[136:151]
    v_cvt_pk_bf16_f32 v158, v196, v197
    v_cvt_pk_bf16_f32 v159, v198, v199
    ds_write_b128 v2, v[32:35] offset:32
    ds_write_b128 v2, v[36:39] offset:48
    v_mfma_f32_32x32x16_bf16 v[120:135], v[152:155], v[168:171], v[120:135]
    v_cvt_pk_bf16_f32 v56, v216, v217
    v_cvt_pk_bf16_f32 v57, v218, v219
    v_cvt_pk_bf16_f32 v58, v220, v221
    v_cvt_pk_bf16_f32 v59, v222, v223
    v_cvt_pk_bf16_f32 v60, v224, v225
    v_cvt_pk_bf16_f32 v61, v226, v227
    v_mfma_f32_32x32x16_bf16 v[120:135], v[156:159], v[172:175], v[120:135]
    v_cvt_pk_bf16_f32 v62, v228, v229
    v_cvt_pk_bf16_f32 v63, v230, v231
    v_cvt_pk_bf16_f32 v160, v136, v137
    v_cvt_pk_bf16_f32 v161, v138, v139
    v_cvt_pk_bf16_f32 v162, v140, v141
    v_cvt_pk_bf16_f32 v163, v142, v143
    v_lshlrev_b32 v216, 16, v64
    v_and_b32 v217, s31, v64
    v_mfma_f32_32x32x16_bf16 v[120:135], v[160:163], v[176:179], v[120:135]
    v_lshlrev_b32 v218, 16, v65
    v_and_b32 v219, s31, v65
    v_lshlrev_b32 v220, 16, v66
    v_and_b32 v221, s31, v66
    v_lshlrev_b32 v222, 16, v67
    v_and_b32 v223, s31, v67
    v_lshlrev_b32 v224, 16, v68
    v_and_b32 v225, s31, v68
    v_lshlrev_b32 v226, 16, v69
    v_and_b32 v227, s31, v69
    v_lshlrev_b32 v228, 16, v70
    v_and_b32 v229, s31, v70
    v_lshlrev_b32 v230, 16, v71
    v_and_b32 v231, s31, v71
    v_cvt_pk_bf16_f32 v164, v144, v145
    v_cvt_pk_bf16_f32 v165, v146, v147
    v_mfma_f32_32x32x16_bf16 v[216:231], v[152:155], v[200:203], v[216:231]
    v_cvt_pk_bf16_f32 v166, v148, v149
    v_cvt_pk_bf16_f32 v167, v150, v151
    buffer_load_dwordx4 v[92:95], v6, s[76:79], s45 offen sc1 nt
    buffer_load_dwordx4 v[96:99], v6, s[76:79], s46 offen sc1 nt
    buffer_load_dwordx4 v[100:103], v1, s[76:79], s47 offen sc1 nt
    buffer_load_dwordx4 v[104:107], v6, s[76:79], s48 offen sc1 nt
    v_mfma_f32_32x32x16_bf16 v[120:135], v[164:167], v[180:183], v[120:135]
    buffer_load_dwordx4 v[108:111], v6, s[76:79], s49 offen sc1 nt
    buffer_load_dwordx4 v[112:115], v1, s[76:79], s50 offen sc1 nt
    buffer_load_dwordx4 v[116:119], v6, s[76:79], s51 offen sc1 nt
    v_mfma_f32_32x32x16_bf16 v[216:231], v[156:159], v[204:207], v[216:231]
    v_mfma_f32_32x32x16_bf16 v[216:231], v[160:163], v[208:211], v[216:231]
    s_nop 6
    v_cvt_pk_bf16_f32 v40, v120, v121
    v_cvt_pk_bf16_f32 v41, v122, v123
    v_cvt_pk_bf16_f32 v42, v124, v125
    v_cvt_pk_bf16_f32 v43, v126, v127
    ds_write_b128 v2, v[40:43] offset:64
    v_mfma_f32_32x32x16_bf16 v[216:231], v[164:167], v[212:215], v[216:231]
    v_cvt_pk_bf16_f32 v44, v128, v129
    v_cvt_pk_bf16_f32 v45, v130, v131
    v_cvt_pk_bf16_f32 v46, v132, v133
    v_cvt_pk_bf16_f32 v47, v134, v135
    ds_write_b128 v2, v[44:47] offset:80
    ds_read_b128 v[24:27], v12 offset:0
    ds_read_b128 v[28:31], v13 offset:0
    ds_read_b128 v[32:35], v12 offset:2064
    ds_read_b128 v[36:39], v12 offset:3104
    ds_read_b128 v[40:43], v13 offset:3104
    ds_read_b128 v[44:47], v12 offset:5168
    ds_write_b128 v2, v[48:51] offset:0
    ds_write_b128 v2, v[52:55] offset:16
    ds_write_b128 v2, v[56:59] offset:32
    ds_write_b128 v2, v[60:63] offset:48
    v_cvt_pk_bf16_f32 v64, v216, v217
    v_cvt_pk_bf16_f32 v65, v218, v219
    v_cvt_pk_bf16_f32 v66, v220, v221
    v_cvt_pk_bf16_f32 v67, v222, v223
    ds_write_b128 v2, v[64:67] offset:64
    v_cvt_pk_bf16_f32 v68, v224, v225
    v_cvt_pk_bf16_f32 v69, v226, v227
    v_cvt_pk_bf16_f32 v70, v228, v229
    v_cvt_pk_bf16_f32 v71, v230, v231
    ds_write_b128 v2, v[68:71] offset:80
    ds_read_b128 v[48:51], v12 offset:0
    ds_read_b128 v[52:55], v13 offset:0
    ds_read_b128 v[56:59], v12 offset:2064
    ds_read_b128 v[60:63], v12 offset:3104
    ds_read_b128 v[64:67], v13 offset:3104
    s_waitcnt lgkmcnt(6)
    buffer_store_dwordx4 v[24:27], v6, s[12:15], s52 offen sc1 nt
    ds_read_b128 v[68:71], v12 offset:5168
    buffer_store_dwordx4 v[28:31], v11, s[12:15], s53 offen sc1 nt
    buffer_store_dwordx4 v[32:35], v6, s[12:15], s54 offen sc1 nt
    buffer_store_dwordx4 v[36:39], v6, s[12:15], s55 offen sc1 nt
    buffer_store_dwordx4 v[40:43], v11, s[12:15], s56 offen sc1 nt
    buffer_store_dwordx4 v[44:47], v6, s[12:15], s57 offen sc1 nt
    s_waitcnt lgkmcnt(3)
    buffer_store_dwordx4 v[48:51], v6, s[12:15], s58 offen sc1 nt
    buffer_store_dwordx4 v[52:55], v11, s[12:15], s59 offen sc1 nt
    buffer_store_dwordx4 v[56:59], v6, s[12:15], s60 offen sc1 nt
    s_waitcnt lgkmcnt(1)
    buffer_store_dwordx4 v[60:63], v6, s[12:15], s61 offen sc1 nt
    buffer_store_dwordx4 v[64:67], v11, s[12:15], s62 offen sc1 nt
    s_waitcnt lgkmcnt(0)
    buffer_store_dwordx4 v[68:71], v6, s[12:15], s63 offen sc1 nt
    s_nop 12
L_next:
    s_mov_b32 s96, s98
    s_mov_b32 s98, s84
    s_mov_b32 s84, 61440
    s_cmp_lt_u32 s96, 12288
    s_cbranch_scc1 L_loop
    s_cmp_lt_u32 s96, 61440
    s_cbranch_scc1 L_sonly
    s_branch L_fin
L_tonly:
    s_and_b32 s86, s98, 0xfff
    s_mul_hi_u32 s37, s86, 153391690
    s_mul_i32 s38, s37, 28
    s_sub_u32 s38, s86, s38
    s_mul_i32 s37, s37, 344064
    s_mul_i32 s38, s38, 1536
    s_add_u32 s87, s37, s38
    s_cmp_ge_u32 s98, 12288
    s_cbranch_scc1 L_pfS1
L_pfX1:
    s_mov_b32 s76, s8
    s_mov_b32 s77, s9
    s_mov_b32 s78, s10
    s_mov_b32 s79, s11
    v_mov_b32 v1, v7
    s_mul_i32 s38, s34, 86016
    s_add_u32 s38, s38, s87
    s_add_u32 s40, s38, 0
    s_add_u32 s41, s38, 0
    s_add_u32 s42, s38, 9634304
    s_add_u32 s43, s38, 19267584
    s_add_u32 s44, s38, 19267584
    s_add_u32 s45, s38, 28901888
    s_add_u32 s46, s38, 43008
    s_add_u32 s47, s38, 43008
    s_add_u32 s48, s38, 9677312
    s_add_u32 s49, s38, 19310592
    s_add_u32 s50, s38, 19310592
    s_add_u32 s51, s38, 28944896
    s_branch L_pfE1
L_pfS1:
    s_mov_b32 s39, s87
    s_mov_b32 s87, 0x40000000
    s_cmp_ge_u32 s98, 61440
    s_cbranch_scc1 L_pfX1
    s_mov_b32 s87, s39
    s_sub_u32 s3, s86, 768
    s_and_b32 s37, s3, 0xfffc
    v_mov_b32 v14, s37
    s_and_b32 s3, s3, 3
    s_lshl_b32 s3, s3, 3
L_flag1:
    global_load_dword v15, v14, s[90:91] sc1
    s_waitcnt vmcnt(0)
    v_readfirstlane_b32 s37, v15
    s_nop 3
    s_lshr_b32 s37, s37, s3
    s_and_b32 s37, s37, 0xff
    s_cmp_ge_u32 s37, 4
    s_cbranch_scc1 L_flag_go1
    s_sleep 40
    s_branch L_flag1
L_flag_go1:
    s_mov_b32 s76, s4
    s_mov_b32 s77, s5
    s_mov_b32 s78, s6
    s_mov_b32 s79, s7
    v_mov_b32 v1, v11
    s_mul_i32 s38, s34, 9633792
    s_add_u32 s38, s38, s87
    s_add_u32 s40, s38, 0
    s_add_u32 s41, s38, 0
    s_add_u32 s42, s38, 86528
    s_add_u32 s43, s38, 172032
    s_add_u32 s44, s38, 172032
    s_add_u32 s45, s38, 258560
    s_add_u32 s46, s38, 43008
    s_add_u32 s47, s38, 43008
    s_add_u32 s48, s38, 129536
    s_add_u32 s49, s38, 215040
    s_add_u32 s50, s38, 215040
    s_add_u32 s51, s38, 301568
L_pfE1:
    buffer_load_dwordx4 v[72:75], v6, s[76:79], s40 offen sc1 nt
    buffer_load_dwordx4 v[76:79], v1, s[76:79], s41 offen sc1 nt
    buffer_load_dwordx4 v[80:83], v6, s[76:79], s42 offen sc1 nt
    buffer_load_dwordx4 v[84:87], v6, s[76:79], s43 offen sc1 nt
    buffer_load_dwordx4 v[88:91], v1, s[76:79], s44 offen sc1 nt
    buffer_load_dwordx4 v[92:95], v6, s[76:79], s45 offen sc1 nt
    buffer_load_dwordx4 v[96:99], v6, s[76:79], s46 offen sc1 nt
    buffer_load_dwordx4 v[100:103], v1, s[76:79], s47 offen sc1 nt
    buffer_load_dwordx4 v[104:107], v6, s[76:79], s48 offen sc1 nt
    buffer_load_dwordx4 v[108:111], v6, s[76:79], s49 offen sc1 nt
    buffer_load_dwordx4 v[112:115], v1, s[76:79], s50 offen sc1 nt
    buffer_load_dwordx4 v[116:119], v6, s[76:79], s51 offen sc1 nt
    s_mul_i32 s38, s34, 86016
    s_add_u32 s38, s38, s89
    s_add_u32 s52, s38, 0
    s_add_u32 s53, s38, 0
    s_add_u32 s54, s38, 9634304
    s_add_u32 s55, s38, 19267584
    s_add_u32 s56, s38, 19267584
    s_add_u32 s57, s38, 28901888
    s_add_u32 s58, s38, 43008
    s_add_u32 s59, s38, 43008
    s_add_u32 s60, s38, 9677312
    s_add_u32 s61, s38, 19310592
    s_add_u32 s62, s38, 19310592
    s_add_u32 s63, s38, 28944896
    ds_write_b128 v2, v[24:27] offset:0
    ds_write_b128 v2, v[28:31] offset:16
    ds_write_b128 v2, v[32:35] offset:32
    ds_write_b128 v2, v[36:39] offset:48
    ds_write_b128 v2, v[40:43] offset:64
    ds_write_b128 v2, v[44:47] offset:80
    ds_read_b128 v[24:27], v12 offset:0
    ds_read_b128 v[28:31], v13 offset:0
    ds_read_b128 v[32:35], v12 offset:2064
    ds_read_b128 v[36:39], v12 offset:3104
    ds_read_b128 v[40:43], v13 offset:3104
    ds_read_b128 v[44:47], v12 offset:5168
    s_waitcnt lgkmcnt(0)
    buffer_store_dwordx4 v[24:27], v6, s[4:7], s52 offen sc1
    buffer_store_dwordx4 v[28:31], v7, s[4:7], s53 offen sc1
    buffer_store_dwordx4 v[32:35], v6, s[4:7], s54 offen sc1
    buffer_store_dwordx4 v[36:39], v6, s[4:7], s55 offen sc1
    buffer_store_dwordx4 v[40:43], v7, s[4:7], s56 offen sc1
    buffer_store_dwordx4 v[44:47], v6, s[4:7], s57 offen sc1
    ds_write_b128 v2, v[48:51] offset:0
    ds_write_b128 v2, v[52:55] offset:16
    ds_write_b128 v2, v[56:59] offset:32
    ds_write_b128 v2, v[60:63] offset:48
    ds_write_b128 v2, v[64:67] offset:64
    ds_write_b128 v2, v[68:71] offset:80
    ds_read_b128 v[48:51], v12 offset:0
    ds_read_b128 v[52:55], v13 offset:0
    ds_read_b128 v[56:59], v12 offset:2064
    ds_read_b128 v[60:63], v12 offset:3104
    ds_read_b128 v[64:67], v13 offset:3104
    ds_read_b128 v[68:71], v12 offset:5168
    s_waitcnt lgkmcnt(0)
    buffer_store_dwordx4 v[48:51], v6, s[4:7], s58 offen sc1
    buffer_store_dwordx4 v[52:55], v7, s[4:7], s59 offen sc1
    buffer_store_dwordx4 v[56:59], v6, s[4:7], s60 offen sc1
    buffer_store_dwordx4 v[60:63], v6, s[4:7], s61 offen sc1
    buffer_store_dwordx4 v[64:67], v7, s[4:7], s62 offen sc1
    buffer_store_dwordx4 v[68:71], v6, s[4:7], s63 offen sc1
    s_sub_u32 s3, s35, 768
    s_and_b32 s37, s3, 0xfffc
    v_mov_b32 v14, s37
    s_and_b32 s3, s3, 3
    s_lshl_b32 s3, s3, 3
    s_lshl_b32 s37, 1, s3
    v_mov_b32 v15, s37
    s_waitcnt vmcnt(0)
    s_mov_b64 exec, 1
    global_atomic_add v14, v15, s[90:91]
    s_mov_b64 exec, -1
    s_waitcnt vmcnt(0)
    s_branch L_next
L_sonly:
    s_and_b32 s35, s96, 0xfff
    s_mul_hi_u32 s37, s35, 153391690
    s_mul_i32 s38, s37, 28
    s_sub_u32 s38, s35, s38
    s_mul_i32 s37, s37, 344064
    s_mul_i32 s38, s38, 1536
    s_add_u32 s89, s37, s38
    s_mul_i32 s38, s34, 9633792
    s_add_u32 s38, s38, s89
    s_add_u32 s52, s38, 0
    s_add_u32 s53, s38, 0
    s_add_u32 s54, s38, 86528
    s_add_u32 s55, s38, 172032
    s_add_u32 s56, s38, 172032
    s_add_u32 s57, s38, 258560
    s_add_u32 s58, s38, 43008
    s_add_u32 s59, s38, 43008
    s_add_u32 s60, s38, 129536
    s_add_u32 s61, s38, 215040
    s_add_u32 s62, s38, 215040
    s_add_u32 s63, s38, 301568
    s_and_b32 s86, s98, 0xfff
    s_mul_hi_u32 s37, s86, 153391690
    s_mul_i32 s38, s37, 28
    s_sub_u32 s38, s86, s38
    s_mul_i32 s37, s37, 344064
    s_mul_i32 s38, s38, 1536
    s_add_u32 s87, s37, s38
    s_cmp_ge_u32 s98, 12288
    s_cbranch_scc1 L_pfS2
L_pfX2:
    s_mov_b32 s76, s8
    s_mov_b32 s77, s9
    s_mov_b32 s78, s10
    s_mov_b32 s79, s11
    v_mov_b32 v1, v7
    s_mul_i32 s38, s34, 86016
    s_add_u32 s38, s38, s87
    s_add_u32 s40, s38, 0
    s_add_u32 s41, s38, 0
    s_add_u32 s42, s38, 9634304
    s_add_u32 s43, s38, 19267584
    s_add_u32 s44, s38, 19267584
    s_add_u32 s45, s38, 28901888
    s_add_u32 s46, s38, 43008
    s_add_u32 s47, s38, 43008
    s_add_u32 s48, s38, 9677312
    s_add_u32 s49, s38, 19310592
    s_add_u32 s50, s38, 19310592
    s_add_u32 s51, s38, 28944896
    s_branch L_pfE2
L_pfS2:
    s_mov_b32 s39, s87
    s_mov_b32 s87, 0x40000000
    s_cmp_ge_u32 s98, 61440
    s_cbranch_scc1 L_pfX2
    s_mov_b32 s87, s39
    s_sub_u32 s3, s86, 768
    s_and_b32 s37, s3, 0xfffc
    v_mov_b32 v14, s37
    s_and_b32 s3, s3, 3
    s_lshl_b32 s3, s3, 3
L_flag2:
    global_load_dword v15, v14, s[90:91] sc1
    s_waitcnt vmcnt(0)
    v_readfirstlane_b32 s37, v15
    s_nop 3
    s_lshr_b32 s37, s37, s3
    s_and_b32 s37, s37, 0xff
    s_cmp_ge_u32 s37, 4
    s_cbranch_scc1 L_flag_go2
    s_sleep 40
    s_branch L_flag2
L_flag_go2:
    s_mov_b32 s76, s4
    s_mov_b32 s77, s5
    s_mov_b32 s78, s6
    s_mov_b32 s79, s7
    v_mov_b32 v1, v11
    s_mul_i32 s38, s34, 9633792
    s_add_u32 s38, s38, s87
    s_add_u32 s40, s38, 0
    s_add_u32 s41, s38, 0
    s_add_u32 s42, s38, 86528
    s_add_u32 s43, s38, 172032
    s_add_u32 s44, s38, 172032
    s_add_u32 s45, s38, 258560
    s_add_u32 s46, s38, 43008
    s_add_u32 s47, s38, 43008
    s_add_u32 s48, s38, 129536
    s_add_u32 s49, s38, 215040
    s_add_u32 s50, s38, 215040
    s_add_u32 s51, s38, 301568
L_pfE2:
    s_waitcnt vmcnt(12)
    ds_write_b128 v12, v[72:75] offset:0
    ds_write_b128 v13, v[76:79] offset:0
    ds_write_b128 v12, v[80:83] offset:2064
    ds_write_b128 v12, v[84:87] offset:3104
    ds_write_b128 v13, v[88:91] offset:3104
    ds_write_b128 v12, v[92:95] offset:5168
    ds_read_b128 v[24:27], v2 offset:0
    ds_read_b128 v[28:31], v2 offset:16
    ds_read_b128 v[32:35], v2 offset:32
    ds_read_b128 v[36:39], v2 offset:48
    ds_read_b128 v[40:43], v2 offset:64
    ds_read_b128 v[44:47], v2 offset:80
    ds_write_b128 v12, v[96:99] offset:0
    ds_write_b128 v13, v[100:103] offset:0
    ds_write_b128 v12, v[104:107] offset:2064
    ds_write_b128 v12, v[108:111] offset:3104
    ds_write_b128 v13, v[112:115] offset:3104
    ds_write_b128 v12, v[116:119] offset:5168
    ds_read_b128 v[48:51], v2 offset:0
    ds_read_b128 v[52:55], v2 offset:16
    ds_read_b128 v[56:59], v2 offset:32
    ds_read_b128 v[60:63], v2 offset:48
    ds_read_b128 v[64:67], v2 offset:64
    ds_read_b128 v[68:71], v2 offset:80
    s_waitcnt lgkmcnt(0)
    s_mov_b64 s[82:83], 0
    s_branch L_S
L_fin:
L_end:
    s_endpgm
.section .rodata,"a"
.p2align 6
.amdhsa_kernel standalone__video_video_swin__vision_kernel
  .amdhsa_next_free_vgpr 256
  .amdhsa_next_free_sgpr 102
  .amdhsa_accum_offset 256
  .amdhsa_group_segment_fixed_size 0
  .amdhsa_kernarg_size 64
  .amdhsa_user_sgpr_count 2
  .amdhsa_user_sgpr_kernarg_segment_ptr 1
  .amdhsa_system_sgpr_workgroup_id_x 1
.end_amdhsa_kernel
```
